```python
import torch

def _softmax(x, axis=-1):
    return torch.softmax(x, dim=axis)
def _gelu(x):
    return torch.nn.functional.gelu(x, approximate="tanh")
def _silu(x):
    return torch.nn.functional.silu(x)
def _sigmoid(x):
    return torch.sigmoid(x)
def _layernorm(x, axis=-1, eps=1e-5):
    m = x.mean(dim=axis, keepdim=True)
    v = x.var(dim=axis, keepdim=True, unbiased=False)
    return (x - m) / torch.sqrt(v + eps)
def _scatter_add(tgt, idx, src, axis=0):
    return tgt.clone().index_add_(axis, idx, src)
def _segment_sum(src, seg, n):
    out = torch.zeros((n,) + src.shape[1:], dtype=src.dtype)
    return out.index_add_(0, seg, src)
def _pad(x, pw):
    flat = tuple(v for pair in reversed(pw) for v in pair)
    return torch.nn.functional.pad(x, flat)

kernel_name = 'interleave_layers__linear_kernel_hedgehog__geglu_ffn__prompt'

def setup_inputs():

    _w = (lambda a: (lambda t: t.to(torch.bfloat16) if t.is_floating_point() else t)(torch.as_tensor(a)))
    def _A_setup():
        B, S, D, H = 1, 2048, 448, 16
        Dh = D // H
        return {
            "x": _w((lambda *s: torch.randn(*s, dtype=torch.bfloat16) * 0.05)(B, S, D)),
            "wqkv": _w((lambda *s: torch.randn(*s, dtype=torch.bfloat16) * 0.2)(D, 3 * D)),
            "w_phi": _w((lambda *s: torch.randn(*s, dtype=torch.bfloat16) * 0.2)(H, Dh, Dh) * (Dh ** -0.5)),
            "wo": _w((lambda *s: torch.randn(*s, dtype=torch.bfloat16) * 0.05)(D, D)),
        }
    _A_in = _A_setup()

    def _B_setup():
        B, S, D, F = 1, 2048, 448, 1792
        return {
            "x": _w((lambda *s: torch.randn(*s, dtype=torch.bfloat16) * 0.05)(B, S, D)),
            "w_gate": _w((lambda *s: torch.randn(*s, dtype=torch.bfloat16) * 0.05)(D, F)),
            "w_up": _w((lambda *s: torch.randn(*s, dtype=torch.bfloat16) * 0.05)(D, F)),
            "w_down": _w((lambda *s: torch.randn(*s, dtype=torch.bfloat16) * 0.05)(F, D)),
        }
    _B_in = _B_setup()

    return {
        "A_x": _A_in["x"],
        "A_wqkv": _A_in["wqkv"],
        "A_w_phi": _A_in["w_phi"],
        "A_wo": _A_in["wo"],
        "B_x": _B_in["x"],
        "B_w_gate": _B_in["w_gate"],
        "B_w_up": _B_in["w_up"],
        "B_w_down": _B_in["w_down"],
    }

def reference(A_x, A_wqkv, A_w_phi, A_wo, B_x, B_w_gate, B_w_up, B_w_down):
    def _A_ref(x, wqkv, w_phi, wo):
        B, S, D = x.shape
        H = 16; Dh = D // H
        qkv = (lambda x, *d: x.permute(*d))((x @ wqkv).reshape(B, S, 3, H, Dh), 2, 0, 3, 1, 4)
        q, k, v = qkv[0], qkv[1], qkv[2]
        pq = torch.einsum("bhsd,hdf->bhsf", q, w_phi)
        pk = torch.einsum("bhsd,hdf->bhsf", k, w_phi)
        phi_q = torch.concatenate([_softmax(pq, axis=-1), _softmax(-pq, axis=-1)], axis=-1)
        phi_k = torch.concatenate([_softmax(pk, axis=-1), _softmax(-pk, axis=-1)], axis=-1)
        kv = torch.einsum("bhsf,bhsd->bhfd", phi_k, v)
        z  = torch.einsum("bhsf->bhf", phi_k)
        num = torch.einsum("bhqf,bhfd->bhqd", phi_q, kv)
        den = torch.einsum("bhqf,bhf->bhq", phi_q, z)[..., None] + 1e-6
        o = num / den
        return (lambda x, *d: x.permute(*d))(o, 0, 2, 1, 3).reshape(B, S, D) @ wo

    def _B_ref(x, w_gate, w_up, w_down):
        return (_gelu(x @ w_gate) * (x @ w_up)) @ w_down

    x = A_x
    x = x + _A_ref(_layernorm(x, axis=-1), A_wqkv, A_w_phi, A_wo)
    x = x + _B_ref(_layernorm(x, axis=-1), B_w_gate, B_w_up, B_w_down)
    x = x + _A_ref(_layernorm(x, axis=-1), A_wqkv, A_w_phi, A_wo)
    x = x + _B_ref(_layernorm(x, axis=-1), B_w_gate, B_w_up, B_w_down)
    return x
```

```asm
; @launch kernel=prep_kernel grid=(256,1,1) block=(256,1,1) lds=33792
; @launch kernel=main_kernel grid=(256,1,1) block=(256,1,1) lds=163840
.amdgcn_target "amdgcn-amd-amdhsa--gfx950"
.text
.globl prep_kernel
.p2align 8
.type prep_kernel,@function
prep_kernel:
    s_cmp_lt_u32 s2, 256
    s_cbranch_scc1 prep_kernel_go
    s_endpgm
prep_kernel_go:
    s_load_dwordx16 s[64:79], s[0:1], 0
    s_load_dwordx2 s[4:5], s[0:1], 80
    v_and_b32 v7, 63, v0
    v_lshlrev_b32 v1, 4, v7
    v_and_b32 v2, 31, v0
    v_bfe_u32 v3, v0, 5, 1
    v_lshrrev_b32 v4, 6, v0
    s_nop 0
    v_readfirstlane_b32 s12, v4
    v_bfe_u32 v8, v7, 2, 2
    v_and_b32 v9, 3, v7
    v_bfe_u32 v10, v7, 4, 1
    v_lshl_add_u32 v8, v3, 2, v8
    v_lshlrev_b32 v8, 6, v8
    v_lshlrev_b32 v11, 5, v10
    v_lshl_add_u32 v11, v9, 3, v11
    v_add_u32 v8, v8, v11
    s_lshl_b32 s13, s12, 13
    v_add_u32 v8, s13, v8
    v_lshrrev_b32 v12, 2, v7
    v_lshlrev_b32 v13, 4, v9
    s_waitcnt lgkmcnt(0)
    s_mov_b32 s6, 37171200
    s_mov_b32 s7, 0x20000
    s_cmp_ge_u32 s2, 224
    s_cbranch_scc1 prep_kernel_nox
    s_mov_b32 s8, s64
    s_mov_b32 s9, s65
    s_mov_b32 s10, 1835008
    s_mov_b32 s11, 0x20000
    s_mul_i32 s13, s2, 9363
    s_lshr_b32 s13, s13, 16
    s_mul_i32 s14, s13, 7
    s_sub_u32 s14, s2, s14
    s_lshr_b32 s15, s12, 1
    s_lshl_b32 s13, s13, 1
    s_add_u32 s30, s13, s15
    s_and_b32 s15, s12, 1
    s_lshl_b32 s14, s14, 1
    s_add_u32 s31, s14, s15
    v_mul_u32_u24 v4, 896, v2
    v_lshlrev_b32 v5, 3, v3
    v_add_u32 v4, v4, v5
    s_mul_i32 s20, s30, 28672
    s_lshl_b32 s15, s31, 6
    s_add_u32 s20, s20, s15
    buffer_load_dwordx2 v[64:65], v4, s[8:11], s20 offen offset:0
    buffer_load_dwordx2 v[66:67], v4, s[8:11], s20 offen offset:16
    buffer_load_dwordx2 v[68:69], v4, s[8:11], s20 offen offset:32
    buffer_load_dwordx2 v[70:71], v4, s[8:11], s20 offen offset:48
prep_kernel_nox:
    s_cmp_lt_u32 s2, 48
    s_cbranch_scc1 prep_kernel_A
    s_cmp_lt_u32 s2, 160
    s_cbranch_scc1 prep_kernel_B
    s_cmp_lt_u32 s2, 209
    s_cbranch_scc1 prep_kernel_Dn
    s_cmp_lt_u32 s2, 216
    s_cbranch_scc1 prep_kernel_pdone0
    s_cmp_lt_u32 s2, 232
    s_cbranch_scc1 prep_kernel_C
    s_cmp_lt_u32 s2, 255
    s_cbranch_scc1 prep_kernel_pdone0
    v_mov_b32 v16, 0
    v_mov_b32 v17, 0
    v_mov_b32 v18, 0
    v_mov_b32 v19, 0
    v_lshlrev_b32 v5, 4, v0
    s_mov_b32 s20, 36077568
    buffer_store_dwordx4 v[16:19], v5, s[4:7], s20 offen
    s_add_u32 s20, s20, 4096
    buffer_store_dwordx4 v[16:19], v5, s[4:7], s20 offen
    s_add_u32 s20, s20, 4096
    buffer_store_dwordx4 v[16:19], v5, s[4:7], s20 offen
    s_add_u32 s20, s20, 4096
    buffer_store_dwordx4 v[16:19], v5, s[4:7], s20 offen
    s_add_u32 s20, s20, 4096
    buffer_store_dwordx4 v[16:19], v5, s[4:7], s20 offen
    s_add_u32 s20, s20, 4096
    buffer_store_dwordx4 v[16:19], v5, s[4:7], s20 offen
    s_add_u32 s20, s20, 4096
    buffer_store_dwordx4 v[16:19], v5, s[4:7], s20 offen
    s_add_u32 s20, s20, 4096
    buffer_store_dwordx4 v[16:19], v5, s[4:7], s20 offen
    s_add_u32 s20, s20, 4096
    buffer_store_dwordx4 v[16:19], v5, s[4:7], s20 offen
    s_add_u32 s20, s20, 4096
    buffer_store_dwordx4 v[16:19], v5, s[4:7], s20 offen
    s_add_u32 s20, s20, 4096
    buffer_store_dwordx4 v[16:19], v5, s[4:7], s20 offen
    s_add_u32 s20, s20, 4096
    s_mov_b32 s8, s68
    s_mov_b32 s9, s69
    s_mov_b32 s10, 25088
    s_mov_b32 s11, 0x20000
    v_mov_b32 v4, v1
    s_mul_i32 s20, s12, 6272
    s_mov_b32 s21, 1024
    s_lshl_b32 s22, s12, 13
    s_mov_b32 m0, s22
    s_nop 0
    buffer_load_dwordx4 v4, s[8:11], s20 offen lds
    s_add_u32 s20, s20, s21
    s_add_u32 s22, s22, 1024
    s_mov_b32 m0, s22
    s_nop 0
    buffer_load_dwordx4 v4, s[8:11], s20 offen lds
    s_add_u32 s20, s20, s21
    s_add_u32 s22, s22, 1024
    s_mov_b32 m0, s22
    s_nop 0
    buffer_load_dwordx4 v4, s[8:11], s20 offen lds
    s_add_u32 s20, s20, s21
    s_add_u32 s22, s22, 1024
    s_mov_b32 m0, s22
    s_nop 0
    buffer_load_dwordx4 v4, s[8:11], s20 offen lds
    s_add_u32 s20, s20, s21
    s_add_u32 s22, s22, 1024
    s_mov_b32 m0, s22
    s_nop 0
    buffer_load_dwordx4 v4, s[8:11], s20 offen lds
    s_add_u32 s20, s20, s21
    s_add_u32 s22, s22, 1024
    s_mov_b32 m0, s22
    s_nop 0
    buffer_load_dwordx4 v4, s[8:11], s20 offen lds
    s_add_u32 s20, s20, s21
    s_add_u32 s22, s22, 1024
    s_mov_b32 m0, s22
    s_nop 0
    buffer_load_dwordx4 v4, s[8:11], s20 offen lds
    v_and_b32 v9, 3, v7
    v_bfe_u32 v10, v7, 4, 1
    v_bfe_u32 v11, v7, 2, 2
    v_lshl_add_u32 v14, v10, 2, v9
    v_min_u32 v14, 6, v14
    v_lshlrev_b32 v14, 3, v14
    v_lshl_add_u32 v11, v3, 2, v11
    v_mul_u32_u24 v11, 56, v11
    v_add_u32 v8, v11, v14
    s_lshl_b32 s13, s12, 13
    v_add_u32 v8, s13, v8
    v_mov_b32 v14, 196608
    v_cmp_eq_u32 vcc, 0, v3
    s_nop 1
    v_cndmask_b32 v9, v14, v8, vcc
    s_lshl_b32 s24, s12, 13
    s_add_u32 s24, s24, 1425408
    s_waitcnt vmcnt(0)
    ds_read_b64_tr_b16 v[16:17], v8 offset:0
    ds_read_b64_tr_b16 v[18:19], v8 offset:448
    ds_read_b64_tr_b16 v[20:21], v8 offset:896
    ds_read_b64_tr_b16 v[22:23], v9 offset:1344
    ds_read_b64_tr_b16 v[24:25], v8 offset:1568
    ds_read_b64_tr_b16 v[26:27], v8 offset:2016
    ds_read_b64_tr_b16 v[28:29], v8 offset:2464
    ds_read_b64_tr_b16 v[30:31], v9 offset:2912
    ds_read_b64_tr_b16 v[32:33], v8 offset:3136
    ds_read_b64_tr_b16 v[34:35], v8 offset:3584
    ds_read_b64_tr_b16 v[36:37], v8 offset:4032
    ds_read_b64_tr_b16 v[38:39], v9 offset:4480
    ds_read_b64_tr_b16 v[40:41], v8 offset:4704
    ds_read_b64_tr_b16 v[42:43], v8 offset:5152
    ds_read_b64_tr_b16 v[44:45], v8 offset:5600
    ds_read_b64_tr_b16 v[46:47], v9 offset:6048
    s_waitcnt lgkmcnt(14)
    buffer_store_dwordx4 v[16:19], v1, s[4:7], s24 offen
    s_add_u32 s24, s24, 1024
    s_waitcnt lgkmcnt(12)
    buffer_store_dwordx4 v[20:23], v1, s[4:7], s24 offen
    s_add_u32 s24, s24, 1024
    s_waitcnt lgkmcnt(10)
    buffer_store_dwordx4 v[24:27], v1, s[4:7], s24 offen
    s_add_u32 s24, s24, 1024
    s_waitcnt lgkmcnt(8)
    buffer_store_dwordx4 v[28:31], v1, s[4:7], s24 offen
    s_add_u32 s24, s24, 1024
    s_waitcnt lgkmcnt(6)
    buffer_store_dwordx4 v[32:35], v1, s[4:7], s24 offen
    s_add_u32 s24, s24, 1024
    s_waitcnt lgkmcnt(4)
    buffer_store_dwordx4 v[36:39], v1, s[4:7], s24 offen
    s_add_u32 s24, s24, 1024
    s_waitcnt lgkmcnt(2)
    buffer_store_dwordx4 v[40:43], v1, s[4:7], s24 offen
    s_add_u32 s24, s24, 1024
    s_waitcnt lgkmcnt(0)
    buffer_store_dwordx4 v[44:47], v1, s[4:7], s24 offen
    s_add_u32 s24, s24, 1024
    s_nop 0
    s_branch prep_kernel_pdone
prep_kernel_A:
    s_mov_b32 s8, s66
    s_mov_b32 s9, s67
    s_mov_b32 s10, 1204224
    s_mov_b32 s11, 0x20000
    s_and_b32 s13, s2, 7
    s_lshr_b32 s14, s2, 3
    s_lshl_b32 s13, s13, 1
    s_and_b32 s15, s14, 1
    s_add_u32 s13, s13, s15
    s_lshr_b32 s14, s14, 1
    s_mul_i32 s18, s13, 3
    s_add_u32 s18, s18, s14
    s_mul_i32 s18, s18, 29696
    s_add_u32 s18, s18, 0
    s_mul_i32 s14, s14, 896
    s_mul_i32 s13, s13, 56
    s_add_u32 s15, s13, s14
    s_mov_b32 s16, 2688
    v_and_b32 v11, v10, v9
    v_lshrrev_b32 v14, 1, v9
    v_and_b32 v11, v11, v14
    v_cmp_eq_u32 vcc, 1, v11
    v_mov_b32 v14, 196608
    s_nop 0
    v_cndmask_b32 v8, v8, v14, vcc
    s_nop 1
    s_branch prep_kernel_AB
prep_kernel_B:
    s_sub_u32 s13, s2, 48
    s_and_b32 s14, s13, 7
    s_lshr_b32 s13, s13, 3
    s_and_b32 s15, s13, 1
    s_lshr_b32 s13, s13, 1
    s_lshl_b32 s13, s13, 3
    s_add_u32 s13, s13, s14
    s_and_b32 s14, s13, 1
    s_lshr_b32 s13, s13, 1
    s_lshl_b32 s13, s13, 1
    s_add_u32 s13, s13, s15
    s_lshl_b32 s13, s13, 1
    s_add_u32 s13, s13, s14
    s_cmp_eq_u32 s14, 0
    s_cselect_b32 s8, s74, s76
    s_cselect_b32 s9, s75, s77
    s_mov_b32 s10, 1605632
    s_mov_b32 s11, 0x20000
    s_lshr_b32 s15, s13, 1
    s_lshl_b32 s15, s15, 6
    s_mov_b32 s16, 3584
    s_mul_i32 s18, s13, 29696
    s_add_u32 s18, s18, 1916928
    s_nop 0
prep_kernel_AB:
    v_mul_lo_u32 v4, s16, v12
    v_add3_u32 v4, v4, v13, s15
    s_mul_i32 s20, s12, 112
    s_mul_i32 s20, s20, s16
    s_lshl_b32 s21, s16, 4
    s_lshl_b32 s22, s12, 13
    s_mov_b32 m0, s22
    s_nop 0
    buffer_load_dwordx4 v4, s[8:11], s20 offen lds
    s_add_u32 s20, s20, s21
    s_add_u32 s22, s22, 1024
    s_mov_b32 m0, s22
    s_nop 0
    buffer_load_dwordx4 v4, s[8:11], s20 offen lds
    s_add_u32 s20, s20, s21
    s_add_u32 s22, s22, 1024
    s_mov_b32 m0, s22
    s_nop 0
    buffer_load_dwordx4 v4, s[8:11], s20 offen lds
    s_add_u32 s20, s20, s21
    s_add_u32 s22, s22, 1024
    s_mov_b32 m0, s22
    s_nop 0
    buffer_load_dwordx4 v4, s[8:11], s20 offen lds
    s_add_u32 s20, s20, s21
    s_add_u32 s22, s22, 1024
    s_mov_b32 m0, s22
    s_nop 0
    buffer_load_dwordx4 v4, s[8:11], s20 offen lds
    s_add_u32 s20, s20, s21
    s_add_u32 s22, s22, 1024
    s_mov_b32 m0, s22
    s_nop 0
    buffer_load_dwordx4 v4, s[8:11], s20 offen lds
    s_add_u32 s20, s20, s21
    s_add_u32 s22, s22, 1024
    s_mov_b32 m0, s22
    s_nop 0
    buffer_load_dwordx4 v4, s[8:11], s20 offen lds
    s_mov_b32 s23, 0x3f803f80
    s_mul_i32 s24, s12, 7168
    s_add_u32 s24, s24, s18
    s_waitcnt vmcnt(0)
    ds_read_b64_tr_b16 v[16:17], v8 offset:0
    ds_read_b64_tr_b16 v[18:19], v8 offset:512
    ds_read_b64_tr_b16 v[20:21], v8 offset:1024
    ds_read_b64_tr_b16 v[22:23], v8 offset:1536
    ds_read_b64_tr_b16 v[24:25], v8 offset:2048
    ds_read_b64_tr_b16 v[26:27], v8 offset:2560
    ds_read_b64_tr_b16 v[28:29], v8 offset:3072
    ds_read_b64_tr_b16 v[30:31], v8 offset:3584
    ds_read_b64_tr_b16 v[32:33], v8 offset:4096
    ds_read_b64_tr_b16 v[34:35], v8 offset:4608
    ds_read_b64_tr_b16 v[36:37], v8 offset:5120
    ds_read_b64_tr_b16 v[38:39], v8 offset:5632
    ds_read_b64_tr_b16 v[40:41], v8 offset:6144
    ds_read_b64_tr_b16 v[42:43], v8 offset:6656
    v_mov_b32 v48, 0
    v_mov_b32 v49, 0
    s_waitcnt lgkmcnt(12)
    buffer_store_dwordx4 v[16:19], v1, s[4:7], s24 offen
    s_add_u32 s24, s24, 1024
    v_dot2_f32_bf16 v48, v16, s23, v48
    v_dot2_f32_bf16 v49, v17, s23, v49
    v_dot2_f32_bf16 v48, v18, s23, v48
    v_dot2_f32_bf16 v49, v19, s23, v49
    s_waitcnt lgkmcnt(10)
    buffer_store_dwordx4 v[20:23], v1, s[4:7], s24 offen
    s_add_u32 s24, s24, 1024
    v_dot2_f32_bf16 v48, v20, s23, v48
    v_dot2_f32_bf16 v49, v21, s23, v49
    v_dot2_f32_bf16 v48, v22, s23, v48
    v_dot2_f32_bf16 v49, v23, s23, v49
    s_waitcnt lgkmcnt(8)
    buffer_store_dwordx4 v[24:27], v1, s[4:7], s24 offen
    s_add_u32 s24, s24, 1024
    v_dot2_f32_bf16 v48, v24, s23, v48
    v_dot2_f32_bf16 v49, v25, s23, v49
    v_dot2_f32_bf16 v48, v26, s23, v48
    v_dot2_f32_bf16 v49, v27, s23, v49
    s_waitcnt lgkmcnt(6)
    buffer_store_dwordx4 v[28:31], v1, s[4:7], s24 offen
    s_add_u32 s24, s24, 1024
    v_dot2_f32_bf16 v48, v28, s23, v48
    v_dot2_f32_bf16 v49, v29, s23, v49
    v_dot2_f32_bf16 v48, v30, s23, v48
    v_dot2_f32_bf16 v49, v31, s23, v49
    s_waitcnt lgkmcnt(4)
    buffer_store_dwordx4 v[32:35], v1, s[4:7], s24 offen
    s_add_u32 s24, s24, 1024
    v_dot2_f32_bf16 v48, v32, s23, v48
    v_dot2_f32_bf16 v49, v33, s23, v49
    v_dot2_f32_bf16 v48, v34, s23, v48
    v_dot2_f32_bf16 v49, v35, s23, v49
    s_waitcnt lgkmcnt(2)
    buffer_store_dwordx4 v[36:39], v1, s[4:7], s24 offen
    s_add_u32 s24, s24, 1024
    v_dot2_f32_bf16 v48, v36, s23, v48
    v_dot2_f32_bf16 v49, v37, s23, v49
    v_dot2_f32_bf16 v48, v38, s23, v48
    v_dot2_f32_bf16 v49, v39, s23, v49
    s_waitcnt lgkmcnt(0)
    buffer_store_dwordx4 v[40:43], v1, s[4:7], s24 offen
    s_add_u32 s24, s24, 1024
    v_dot2_f32_bf16 v48, v40, s23, v48
    v_dot2_f32_bf16 v49, v41, s23, v49
    v_dot2_f32_bf16 v48, v42, s23, v48
    v_dot2_f32_bf16 v49, v43, s23, v49
    s_nop 2
    v_add_f32 v48, v48, v49
    v_lshlrev_b32 v9, 2, v0
    v_add_u32 v9, 32768, v9
    ds_write_b32 v9, v48
    s_waitcnt lgkmcnt(0)
    s_barrier
    s_cmp_lg_u32 s12, 0
    s_cbranch_scc1 prep_kernel_pdone
    v_lshlrev_b32 v9, 2, v2
    v_add_u32 v9, 32768, v9
    ds_read_b32 v50, v9 offset:0
    ds_read_b32 v51, v9 offset:128
    ds_read_b32 v52, v9 offset:256
    ds_read_b32 v53, v9 offset:384
    ds_read_b32 v54, v9 offset:512
    ds_read_b32 v55, v9 offset:640
    ds_read_b32 v56, v9 offset:768
    ds_read_b32 v57, v9 offset:896
    s_waitcnt lgkmcnt(0)
    v_add_f32 v50, v50, v51
    v_add_f32 v52, v52, v53
    v_add_f32 v54, v54, v55
    v_add_f32 v56, v56, v57
    v_add_f32 v50, v50, v52
    v_add_f32 v54, v54, v56
    v_add_f32 v50, v50, v54
    v_cvt_pk_bf16_f32 v51, v50, v50
    v_lshlrev_b32 v51, 16, v51
    v_sub_f32 v52, v50, v51
    v_cvt_pk_bf16_f32 v52, v51, v52
    v_cmp_eq_u32 vcc, 0, v3
    v_mov_b32 v54, 0
    v_mov_b32 v55, 0
    v_cndmask_b32 v52, v54, v52, vcc
    v_mov_b32 v53, v52
    s_add_u32 s24, s18, 28672
    buffer_store_dwordx4 v[52:55], v1, s[4:7], s24 offen
    s_nop 1
    s_branch prep_kernel_pdone
prep_kernel_C:
    s_mov_b32 s8, s70
    s_mov_b32 s9, s71
    s_mov_b32 s10, 401408
    s_mov_b32 s11, 0x20000
    s_sub_u32 s13, s2, 216
    s_and_b32 s14, s13, 7
    s_lshr_b32 s13, s13, 3
    s_cmp_eq_u32 s14, 7
    s_cbranch_scc1 prep_kernel_pdone0
    s_lshl_b32 s14, s14, 1
    s_add_u32 s13, s13, s14
    s_lshl_b32 s15, s13, 6
    s_mov_b32 s16, 896
    v_mul_lo_u32 v4, s16, v12
    v_add3_u32 v4, v4, v13, s15
    s_mul_i32 s20, s12, 100352
    s_mov_b32 s21, 14336
    s_lshl_b32 s22, s12, 13
    s_mov_b32 m0, s22
    s_nop 0
    buffer_load_dwordx4 v4, s[8:11], s20 offen lds
    s_add_u32 s20, s20, s21
    s_add_u32 s22, s22, 1024
    s_mov_b32 m0, s22
    s_nop 0
    buffer_load_dwordx4 v4, s[8:11], s20 offen lds
    s_add_u32 s20, s20, s21
    s_add_u32 s22, s22, 1024
    s_mov_b32 m0, s22
    s_nop 0
    buffer_load_dwordx4 v4, s[8:11], s20 offen lds
    s_add_u32 s20, s20, s21
    s_add_u32 s22, s22, 1024
    s_mov_b32 m0, s22
    s_nop 0
    buffer_load_dwordx4 v4, s[8:11], s20 offen lds
    s_add_u32 s20, s20, s21
    s_add_u32 s22, s22, 1024
    s_mov_b32 m0, s22
    s_nop 0
    buffer_load_dwordx4 v4, s[8:11], s20 offen lds
    s_add_u32 s20, s20, s21
    s_add_u32 s22, s22, 1024
    s_mov_b32 m0, s22
    s_nop 0
    buffer_load_dwordx4 v4, s[8:11], s20 offen lds
    s_add_u32 s20, s20, s21
    s_add_u32 s22, s22, 1024
    s_mov_b32 m0, s22
    s_nop 0
    buffer_load_dwordx4 v4, s[8:11], s20 offen lds
    v_mov_b32 v14, 196608
    v_cmp_eq_u32 vcc, 0, v3
    s_nop 1
    v_cndmask_b32 v9, v14, v8, vcc
    s_lshl_b32 s24, s13, 5
    s_lshl_b32 s25, s12, 3
    s_add_u32 s24, s24, s25
    s_lshl_b32 s24, s24, 10
    s_add_u32 s24, s24, 1458176
    s_waitcnt vmcnt(0)
    ds_read_b64_tr_b16 v[16:17], v8 offset:0
    ds_read_b64_tr_b16 v[18:19], v8 offset:512
    ds_read_b64_tr_b16 v[20:21], v8 offset:1024
    ds_read_b64_tr_b16 v[22:23], v9 offset:1536
    ds_read_b64_tr_b16 v[24:25], v8 offset:1792
    ds_read_b64_tr_b16 v[26:27], v8 offset:2304
    ds_read_b64_tr_b16 v[28:29], v8 offset:2816
    ds_read_b64_tr_b16 v[30:31], v9 offset:3328
    ds_read_b64_tr_b16 v[32:33], v8 offset:3584
    ds_read_b64_tr_b16 v[34:35], v8 offset:4096
    ds_read_b64_tr_b16 v[36:37], v8 offset:4608
    ds_read_b64_tr_b16 v[38:39], v9 offset:5120
    ds_read_b64_tr_b16 v[40:41], v8 offset:5376
    ds_read_b64_tr_b16 v[42:43], v8 offset:5888
    ds_read_b64_tr_b16 v[44:45], v8 offset:6400
    ds_read_b64_tr_b16 v[46:47], v9 offset:6912
    s_waitcnt lgkmcnt(14)
    buffer_store_dwordx4 v[16:19], v1, s[4:7], s24 offen
    s_add_u32 s24, s24, 1024
    s_waitcnt lgkmcnt(12)
    buffer_store_dwordx4 v[20:23], v1, s[4:7], s24 offen
    s_add_u32 s24, s24, 1024
    s_waitcnt lgkmcnt(10)
    buffer_store_dwordx4 v[24:27], v1, s[4:7], s24 offen
    s_add_u32 s24, s24, 1024
    s_waitcnt lgkmcnt(8)
    buffer_store_dwordx4 v[28:31], v1, s[4:7], s24 offen
    s_add_u32 s24, s24, 1024
    s_waitcnt lgkmcnt(6)
    buffer_store_dwordx4 v[32:35], v1, s[4:7], s24 offen
    s_add_u32 s24, s24, 1024
    s_waitcnt lgkmcnt(4)
    buffer_store_dwordx4 v[36:39], v1, s[4:7], s24 offen
    s_add_u32 s24, s24, 1024
    s_waitcnt lgkmcnt(2)
    buffer_store_dwordx4 v[40:43], v1, s[4:7], s24 offen
    s_add_u32 s24, s24, 1024
    s_waitcnt lgkmcnt(0)
    buffer_store_dwordx4 v[44:47], v1, s[4:7], s24 offen
    s_add_u32 s24, s24, 1024
    s_nop 0
    s_branch prep_kernel_pdone
prep_kernel_Dn:
    s_mov_b32 s8, s78
    s_mov_b32 s9, s79
    s_mov_b32 s10, 1605632
    s_mov_b32 s11, 0x20000
    s_sub_u32 s13, s2, 160
    s_mul_i32 s14, s13, 9363
    s_lshr_b32 s14, s14, 16
    s_mul_i32 s25, s14, 7
    s_sub_u32 s25, s13, s25
    s_lshl_b32 s25, s25, 2
    s_add_u32 s25, s25, s12
    v_lshrrev_b32 v4, 3, v7
    v_mul_u32_u24 v4, 896, v4
    v_and_b32 v5, 7, v7
    v_lshlrev_b32 v5, 4, v5
    s_lshl_b32 s15, s14, 7
    v_add3_u32 v4, v4, v5, s15
    s_mul_i32 s20, s25, 57344
    s_mov_b32 s21, 7168
    s_lshl_b32 s22, s12, 13
    s_mov_b32 m0, s22
    s_nop 0
    buffer_load_dwordx4 v4, s[8:11], s20 offen lds
    s_add_u32 s20, s20, s21
    s_add_u32 s22, s22, 1024
    s_mov_b32 m0, s22
    s_nop 0
    buffer_load_dwordx4 v4, s[8:11], s20 offen lds
    s_add_u32 s20, s20, s21
    s_add_u32 s22, s22, 1024
    s_mov_b32 m0, s22
    s_nop 0
    buffer_load_dwordx4 v4, s[8:11], s20 offen lds
    s_add_u32 s20, s20, s21
    s_add_u32 s22, s22, 1024
    s_mov_b32 m0, s22
    s_nop 0
    buffer_load_dwordx4 v4, s[8:11], s20 offen lds
    s_add_u32 s20, s20, s21
    s_add_u32 s22, s22, 1024
    s_mov_b32 m0, s22
    s_nop 0
    buffer_load_dwordx4 v4, s[8:11], s20 offen lds
    s_add_u32 s20, s20, s21
    s_add_u32 s22, s22, 1024
    s_mov_b32 m0, s22
    s_nop 0
    buffer_load_dwordx4 v4, s[8:11], s20 offen lds
    s_add_u32 s20, s20, s21
    s_add_u32 s22, s22, 1024
    s_mov_b32 m0, s22
    s_nop 0
    buffer_load_dwordx4 v4, s[8:11], s20 offen lds
    s_add_u32 s20, s20, s21
    s_add_u32 s22, s22, 1024
    s_mov_b32 m0, s22
    s_nop 0
    buffer_load_dwordx4 v4, s[8:11], s20 offen lds
    v_bfe_u32 v8, v7, 2, 2
    v_lshl_add_u32 v8, v3, 2, v8
    v_lshlrev_b32 v8, 7, v8
    v_add_u32 v8, v8, v11
    s_lshl_b32 s13, s12, 13
    v_add_u32 v8, s13, v8
    s_mul_i32 s24, s14, 224
    s_lshl_b32 s26, s25, 2
    s_add_u32 s24, s24, s26
    s_lshl_b32 s24, s24, 10
    s_add_u32 s24, s24, 5242880
    s_waitcnt vmcnt(0)
    ds_read_b64_tr_b16 v[16:17], v8 offset:0
    ds_read_b64_tr_b16 v[18:19], v8 offset:1024
    ds_read_b64_tr_b16 v[20:21], v8 offset:2048
    ds_read_b64_tr_b16 v[22:23], v8 offset:3072
    ds_read_b64_tr_b16 v[24:25], v8 offset:4096
    ds_read_b64_tr_b16 v[26:27], v8 offset:5120
    ds_read_b64_tr_b16 v[28:29], v8 offset:6144
    ds_read_b64_tr_b16 v[30:31], v8 offset:7168
    ds_read_b64_tr_b16 v[32:33], v8 offset:64
    ds_read_b64_tr_b16 v[34:35], v8 offset:1088
    ds_read_b64_tr_b16 v[36:37], v8 offset:2112
    ds_read_b64_tr_b16 v[38:39], v8 offset:3136
    ds_read_b64_tr_b16 v[40:41], v8 offset:4160
    ds_read_b64_tr_b16 v[42:43], v8 offset:5184
    ds_read_b64_tr_b16 v[44:45], v8 offset:6208
    ds_read_b64_tr_b16 v[46:47], v8 offset:7232
    s_waitcnt lgkmcnt(14)
    buffer_store_dwordx4 v[16:19], v1, s[4:7], s24 offen
    s_add_u32 s24, s24, 1024
    s_waitcnt lgkmcnt(12)
    buffer_store_dwordx4 v[20:23], v1, s[4:7], s24 offen
    s_add_u32 s24, s24, 1024
    s_waitcnt lgkmcnt(10)
    buffer_store_dwordx4 v[24:27], v1, s[4:7], s24 offen
    s_add_u32 s24, s24, 1024
    s_waitcnt lgkmcnt(8)
    buffer_store_dwordx4 v[28:31], v1, s[4:7], s24 offen
    s_add_u32 s24, s24, 111616
    s_waitcnt lgkmcnt(6)
    buffer_store_dwordx4 v[32:35], v1, s[4:7], s24 offen
    s_add_u32 s24, s24, 1024
    s_waitcnt lgkmcnt(4)
    buffer_store_dwordx4 v[36:39], v1, s[4:7], s24 offen
    s_add_u32 s24, s24, 1024
    s_waitcnt lgkmcnt(2)
    buffer_store_dwordx4 v[40:43], v1, s[4:7], s24 offen
    s_add_u32 s24, s24, 1024
    s_waitcnt lgkmcnt(0)
    buffer_store_dwordx4 v[44:47], v1, s[4:7], s24 offen
    s_add_u32 s24, s24, 1024
    s_nop 0
    s_branch prep_kernel_pdone
prep_kernel_pdone0:
    s_waitcnt vmcnt(0)
prep_kernel_pdone:
    s_cmp_ge_u32 s2, 224
    s_cbranch_scc1 prep_kernel_nox2
    s_mul_i32 s21, s30, 28
    s_lshl_b32 s15, s31, 1
    s_add_u32 s21, s21, s15
    s_lshl_b32 s21, s21, 10
    s_add_u32 s21, s21, 6848512
    s_mul_i32 s22, s30, 3584
    s_lshl_b32 s15, s31, 8
    s_add_u32 s22, s22, s15
    s_add_u32 s22, s22, 14188544
    s_mov_b32 s23, 0x3f803f80
    v_lshlrev_b32 v6, 3, v2
    v_mov_b32 v8, 0
    v_mov_b32 v9, 0
    buffer_store_dwordx4 v[64:67], v1, s[4:7], s21 offen
    buffer_store_dwordx4 v[68:71], v1, s[4:7], s21 offen offset:1024
    v_dot2_f32_bf16 v8, v64, s23, v8
    v_dot2_f32_bf16 v9, v64, v64, v9
    v_dot2_f32_bf16 v8, v65, s23, v8
    v_dot2_f32_bf16 v9, v65, v65, v9
    v_dot2_f32_bf16 v8, v66, s23, v8
    v_dot2_f32_bf16 v9, v66, v66, v9
    v_dot2_f32_bf16 v8, v67, s23, v8
    v_dot2_f32_bf16 v9, v67, v67, v9
    v_dot2_f32_bf16 v8, v68, s23, v8
    v_dot2_f32_bf16 v9, v68, v68, v9
    v_dot2_f32_bf16 v8, v69, s23, v8
    v_dot2_f32_bf16 v9, v69, v69, v9
    v_dot2_f32_bf16 v8, v70, s23, v8
    v_dot2_f32_bf16 v9, v70, v70, v9
    v_dot2_f32_bf16 v8, v71, s23, v8
    v_dot2_f32_bf16 v9, v71, v71, v9
    s_nop 1
    v_mov_b32 v10, v8
    v_mov_b32 v11, v9
    s_nop 0
    v_permlane32_swap_b32 v10, v8
    v_permlane32_swap_b32 v11, v9
    v_add_f32 v12, v8, v10
    v_add_f32 v13, v9, v11
    s_mov_b32 exec_hi, 0
    buffer_store_dwordx2 v[12:13], v6, s[4:7], s22 offen
    s_mov_b32 exec_hi, -1
    s_nop 0
prep_kernel_nox2:
    s_endpgm
.globl main_kernel
.p2align 8
.type main_kernel,@function
main_kernel:
    s_cmp_lt_u32 s2, 256
    s_cbranch_scc1 main_kernel_go
    s_endpgm
main_kernel_go:
    s_load_dwordx2 s[4:5], s[0:1], 80
    s_load_dwordx2 s[8:9], s[0:1], 64
    s_mov_b32 s6, 37171200
    s_mov_b32 s7, 0x20000
    s_mov_b32 s10, 1835008
    s_mov_b32 s11, 0x20000
    s_and_b32 s20, s2, 7
    s_lshr_b32 s21, s2, 3
    s_and_b32 s22, s20, 3
    s_lshr_b32 s20, s20, 2
    s_lshl_b32 s20, s20, 3
    s_and_b32 s12, s21, 7
    s_add_u32 s12, s12, s20
    s_lshr_b32 s21, s21, 3
    s_lshr_b32 s16, s22, 1
    s_and_b32 s23, s22, 1
    s_lshl_b32 s23, s23, 2
    s_add_u32 s30, s23, s21
    s_lshl_b32 s13, s16, 3
    s_add_u32 s13, s13, s30
    s_min_u32 s17, s30, 6
    s_mul_i32 s29, s16, 7
    s_add_u32 s29, s29, s17
    s_lshl_b32 s31, s16, 1
    s_sub_u32 s31, 2, s31
    v_lshrrev_b32 v8, 6, v0
    v_and_b32 v9, 63, v0
    v_lshlrev_b32 v1, 4, v9
    v_readfirstlane_b32 s14, v8
    v_add_u32 v2, 0x10000, v1
    v_and_b32 v10, 31, v0
    v_bfe_u32 v11, v0, 5, 1
    v_lshlrev_b32 v4, 3, v10
    v_mul_u32_u24 v3, 1792, v11
    v_add_u32 v3, v3, v4
    s_lshr_b32 s18, s14, 1
    s_and_b32 s19, s14, 1
    s_mov_b32 s24, 0x3f80
    s_mov_b32 s25, 0x3f800000
    s_mov_b32 s26, 0
    s_mov_b32 s27, -1
    s_mov_b32 s15, 0
    s_lshl_b32 s50, s12, 2
    s_lshl_b32 s23, s16, 1
    s_add_u32 s50, s50, s23
    s_add_u32 s50, s50, s18
    s_lshl_b32 s51, s17, 1
    s_add_u32 s51, s51, s19
    s_lshl_b32 s52, s12, 2
    s_add_u32 s52, s52, s14
    s_waitcnt lgkmcnt(0)
    s_mul_i32 s45, s14, 7168
    s_add_u32 s45, s45, 29696
    s_mul_i32 s44, s13, 89088
    s_mul_i32 s23, s14, 7168
    s_add_u32 s44, s44, s23
    s_add_u32 s44, s44, 29696
    s_mov_b32 m0, s45
    s_nop 0
    buffer_load_dwordx4 v1, s[4:7], s44 offen lds
    buffer_load_dwordx4 v1, s[4:7], s44 offen offset:1024 lds
    buffer_load_dwordx4 v1, s[4:7], s44 offen offset:2048 lds
    buffer_load_dwordx4 v1, s[4:7], s44 offen offset:3072 lds
    s_add_u32 s44, s44, 4096
    s_add_u32 s45, s45, 4096
    s_mov_b32 m0, s45
    s_nop 0
    buffer_load_dwordx4 v1, s[4:7], s44 offen lds
    buffer_load_dwordx4 v1, s[4:7], s44 offen offset:1024 lds
    buffer_load_dwordx4 v1, s[4:7], s44 offen offset:2048 lds
    buffer_load_dwordx4 v1, s[4:7], s44 offen offset:3072 lds
    s_mul_i32 s45, s14, 7168
    s_add_u32 s45, s45, 59392
    s_mul_i32 s44, s13, 89088
    s_mul_i32 s23, s14, 7168
    s_add_u32 s44, s44, s23
    s_add_u32 s44, s44, 59392
    s_mov_b32 m0, s45
    s_nop 0
    buffer_load_dwordx4 v1, s[4:7], s44 offen lds
    buffer_load_dwordx4 v1, s[4:7], s44 offen offset:1024 lds
    buffer_load_dwordx4 v1, s[4:7], s44 offen offset:2048 lds
    buffer_load_dwordx4 v1, s[4:7], s44 offen offset:3072 lds
    s_add_u32 s44, s44, 4096
    s_add_u32 s45, s45, 4096
    s_mov_b32 m0, s45
    s_nop 0
    buffer_load_dwordx4 v1, s[4:7], s44 offen lds
    buffer_load_dwordx4 v1, s[4:7], s44 offen offset:1024 lds
    buffer_load_dwordx4 v1, s[4:7], s44 offen offset:2048 lds
    buffer_load_dwordx4 v1, s[4:7], s44 offen offset:3072 lds
    s_lshl_b32 s20, s13, 11
    s_add_u32 s20, s20, 1425408
    buffer_load_dwordx4 a[232:235], v1, s[4:7], s20 offen
    buffer_load_dwordx4 a[236:239], v1, s[4:7], s20 offen offset:1024
    s_mul_i32 s20, s50, 28672
    s_lshl_b32 s23, s51, 11
    s_add_u32 s20, s20, s23
    s_add_u32 s20, s20, 6848512
    buffer_load_dwordx4 a[248:251], v1, s[4:7], s20 offen
    buffer_load_dwordx4 a[252:255], v1, s[4:7], s20 offen offset:1024
    v_cmp_eq_u32 vcc, 28, v10
    v_mov_b32 v12, 1.0
    v_mov_b32 v5, 0
    v_cndmask_b32 v5, v5, v12, vcc
    v_lshlrev_b32 v11, 2, v11
    v_sub_u32 v10, v10, v11
    v_mov_b32 v12, 0x3f80
    v_mov_b32 v13, 0x3f800000
    v_mov_b32 v14, 0
    v_cmp_eq_u32 vcc, 0, v10
    s_nop 1
    v_cndmask_b32 v14, v14, v12, vcc
    v_cmp_eq_u32 vcc, 1, v10
    s_nop 1
    v_cndmask_b32 v14, v14, v13, vcc
    v_accvgpr_write_b32 a240, v14
    v_mov_b32 v14, 0
    v_cmp_eq_u32 vcc, 2, v10
    s_nop 1
    v_cndmask_b32 v14, v14, v12, vcc
    v_cmp_eq_u32 vcc, 3, v10
    s_nop 1
    v_cndmask_b32 v14, v14, v13, vcc
    v_accvgpr_write_b32 a241, v14
    v_mov_b32 v14, 0
    v_cmp_eq_u32 vcc, 8, v10
    s_nop 1
    v_cndmask_b32 v14, v14, v12, vcc
    v_cmp_eq_u32 vcc, 9, v10
    s_nop 1
    v_cndmask_b32 v14, v14, v13, vcc
    v_accvgpr_write_b32 a242, v14
    v_mov_b32 v14, 0
    v_cmp_eq_u32 vcc, 10, v10
    s_nop 1
    v_cndmask_b32 v14, v14, v12, vcc
    v_cmp_eq_u32 vcc, 11, v10
    s_nop 1
    v_cndmask_b32 v14, v14, v13, vcc
    v_accvgpr_write_b32 a243, v14
    v_mov_b32 v14, 0
    v_cmp_eq_u32 vcc, 16, v10
    s_nop 1
    v_cndmask_b32 v14, v14, v12, vcc
    v_cmp_eq_u32 vcc, 17, v10
    s_nop 1
    v_cndmask_b32 v14, v14, v13, vcc
    v_accvgpr_write_b32 a244, v14
    v_mov_b32 v14, 0
    v_cmp_eq_u32 vcc, 18, v10
    s_nop 1
    v_cndmask_b32 v14, v14, v12, vcc
    v_cmp_eq_u32 vcc, 19, v10
    s_nop 1
    v_cndmask_b32 v14, v14, v13, vcc
    v_accvgpr_write_b32 a245, v14
    v_mov_b32 v14, 0
    v_cmp_eq_u32 vcc, 24, v10
    s_nop 1
    v_cndmask_b32 v14, v14, v12, vcc
    v_cmp_eq_u32 vcc, 25, v10
    s_nop 1
    v_cndmask_b32 v14, v14, v13, vcc
    v_accvgpr_write_b32 a246, v14
    v_mov_b32 v14, 0
    v_cmp_eq_u32 vcc, 26, v10
    s_nop 1
    v_cndmask_b32 v14, v14, v12, vcc
    v_cmp_eq_u32 vcc, 27, v10
    s_nop 1
    v_cndmask_b32 v14, v14, v13, vcc
    v_accvgpr_write_b32 a247, v14
    s_nop 1
main_kernel_layer:
    s_mul_i32 s48, s15, 20480
    s_lshl_b32 s23, s12, 7
    s_add_u32 s48, s48, s23
    s_add_u32 s48, s48, 36077568
    s_mul_i32 s49, s15, 20480
    s_lshl_b32 s23, s13, 7
    s_add_u32 s49, s49, s23
    s_add_u32 s49, s49, 36077568
    s_cmp_eq_u32 s15, 0
    s_cbranch_scc1 nos5_1
    s_add_u32 s22, s48, -6144
    s_cmp_lg_u32 s14, 0
    s_cbranch_scc1 pol_2
    s_mov_b32 s28, 0
    s_mov_b64 exec, 1
    buffer_load_dword v0, off, s[4:7], s22 sc1
plp_3:
    s_waitcnt vmcnt(0)
    v_readlane_b32 s23, v0, 0
    s_nop 0
    s_cmp_ge_u32 s23, 14
    s_nop 2
    s_cbranch_scc1 plx_4
    s_mov_b64 exec, 1
    buffer_load_dword v0, off, s[4:7], s22 sc1
    s_add_u32 s28, s28, 1
    s_cmp_lt_u32 s28, 1000000
    s_cbranch_scc1 plp_3
plx_4:
    s_mov_b64 exec, -1
    s_nop 0
pol_2:
    s_barrier
nos5_1:
    s_mul_i32 s32, s52, 28672
    s_mul_i32 s23, s15, 3670016
    s_add_u32 s32, s32, s23
    s_add_u32 s32, s32, 6848512
    buffer_load_dwordx4 v[16:19], v1, s[4:7], s32 offen sc1
    buffer_load_dwordx4 v[20:23], v1, s[4:7], s32 offen offset:1024 sc1
    s_mul_i32 s33, s52, 3584
    s_mul_i32 s23, s15, 458752
    s_add_u32 s33, s33, s23
    s_add_u32 s33, s33, 14188544
    buffer_load_dwordx2 v[208:209], v3, s[4:7], s33 offen sc1
    buffer_load_dwordx2 v[210:211], v3, s[4:7], s33 offen offset:256 sc1
    buffer_load_dwordx2 v[212:213], v3, s[4:7], s33 offen offset:512 sc1
    buffer_load_dwordx2 v[214:215], v3, s[4:7], s33 offen offset:768 sc1
    buffer_load_dwordx2 v[216:217], v3, s[4:7], s33 offen offset:1024 sc1
    buffer_load_dwordx2 v[218:219], v3, s[4:7], s33 offen offset:1280 sc1
    buffer_load_dwordx2 v[220:221], v3, s[4:7], s33 offen offset:1536 sc1
    buffer_load_dwordx4 v[24:27], v1, s[4:7], s32 offen offset:2048 sc1
    buffer_load_dwordx4 v[28:31], v1, s[4:7], s32 offen offset:3072 sc1
    s_add_u32 s32, s32, 4096
    buffer_load_dwordx4 v[32:35], v1, s[4:7], s32 offen sc1
    buffer_load_dwordx4 v[36:39], v1, s[4:7], s32 offen offset:1024 sc1
    buffer_load_dwordx4 v[40:43], v1, s[4:7], s32 offen offset:2048 sc1
    buffer_load_dwordx4 v[44:47], v1, s[4:7], s32 offen offset:3072 sc1
    s_add_u32 s32, s32, 4096
    buffer_load_dwordx4 v[48:51], v1, s[4:7], s32 offen sc1
    buffer_load_dwordx4 v[52:55], v1, s[4:7], s32 offen offset:1024 sc1
    buffer_load_dwordx4 v[56:59], v1, s[4:7], s32 offen offset:2048 sc1
    buffer_load_dwordx4 v[60:63], v1, s[4:7], s32 offen offset:3072 sc1
    s_add_u32 s32, s32, 4096
    buffer_load_dwordx4 v[64:67], v1, s[4:7], s32 offen sc1
    buffer_load_dwordx4 v[68:71], v1, s[4:7], s32 offen offset:1024 sc1
    s_waitcnt vmcnt(21)
    s_barrier
    ds_read_b128 v[176:179], v1 offset:29696
    ds_read_b128 v[180:183], v1 offset:59392
    ds_read_b128 v[184:187], v1 offset:30720
    ds_read_b128 v[188:191], v1 offset:60416
    ds_read_b128 v[192:195], v1 offset:31744
    ds_read_b128 v[196:199], v1 offset:61440
    ds_read_b128 v[200:203], v1 offset:32768
    ds_read_b128 v[204:207], v1 offset:62464
    buffer_load_dwordx4 v[72:75], v1, s[4:7], s32 offen offset:2048 sc1
    s_waitcnt vmcnt(21) lgkmcnt(6)
    v_mfma_f32_32x32x16_bf16 v[128:143], v[176:179], v[16:19], 0
    s_waitcnt vmcnt(13)
    v_add_f32 v208, v208, v210
    v_add_f32 v212, v212, v214
    v_add_f32 v216, v216, v218
    v_add_f32 v209, v209, v211
    v_add_f32 v213, v213, v215
    v_mfma_f32_32x32x16_bf16 v[144:159], v[16:19], v[180:183], 0
    ds_read_b128 v[176:179], v1 offset:33792
    ds_read_b128 v[180:183], v1 offset:63488
    buffer_load_dwordx4 v[76:79], v1, s[4:7], s32 offen offset:3072 sc1
    s_add_u32 s32, s32, 4096
    s_waitcnt lgkmcnt(6)
    v_mfma_f32_32x32x16_bf16 v[128:143], v[184:187], v[20:23], v[128:143]
    v_add_f32 v217, v217, v219
    v_add_f32 v208, v208, v212
    v_add_f32 v216, v216, v220
    v_add_f32 v209, v209, v213
    v_add_f32 v217, v217, v221
    v_mfma_f32_32x32x16_bf16 v[144:159], v[20:23], v[188:191], v[144:159]
    ds_read_b128 v[184:187], v1 offset:34816
    ds_read_b128 v[188:191], v1 offset:64512
    buffer_load_dwordx4 v[80:83], v1, s[4:7], s32 offen sc1
    s_waitcnt vmcnt(14) lgkmcnt(6)
    v_mfma_f32_32x32x16_bf16 v[128:143], v[192:195], v[24:27], v[128:143]
    v_add_f32 v208, v208, v216
    v_add_f32 v209, v209, v217
    v_mov_b32 v10, v208
    v_mov_b32 v11, v209
    s_nop 0
    v_permlane32_swap_b32 v10, v208
    v_mfma_f32_32x32x16_bf16 v[144:159], v[24:27], v[196:199], v[144:159]
    ds_read_b128 v[192:195], v1 offset:35840
    ds_read_b128 v[196:199], v2 offset:0
    buffer_load_dwordx4 v[84:87], v1, s[4:7], s32 offen offset:1024 sc1
    s_waitcnt vmcnt(14) lgkmcnt(6)
    v_mfma_f32_32x32x16_bf16 v[128:143], v[200:203], v[28:31], v[128:143]
    v_permlane32_swap_b32 v11, v209
    v_add_f32 v208, v208, v10
    v_add_f32 v209, v209, v11
    v_mul_f32 v9, 0x3b124925, v208
    v_mul_f32 v11, 0x3b124925, v209
    v_mfma_f32_32x32x16_bf16 v[144:159], v[28:31], v[204:207], v[144:159]
    ds_read_b128 v[200:203], v1 offset:36864
    ds_read_b128 v[204:207], v2 offset:1024
    buffer_load_dwordx4 v[88:91], v1, s[4:7], s32 offen offset:2048 sc1
    s_waitcnt vmcnt(14) lgkmcnt(6)
    v_mfma_f32_32x32x16_bf16 v[128:143], v[176:179], v[32:35], v[128:143]
    v_mul_f32 v10, v9, v9
    v_sub_f32 v8, v11, v10
    v_max_f32 v8, 0, v8
    v_add_f32 v8, 0x3727c5ac, v8
    v_cvt_pk_bf16_f32 v10, -v9, -v9
    v_mfma_f32_32x32x16_bf16 v[144:159], v[32:35], v[180:183], v[144:159]
    ds_read_b128 v[176:179], v1 offset:37888
    ds_read_b128 v[180:183], v2 offset:2048
    buffer_load_dwordx4 v[92:95], v1, s[4:7], s32 offen offset:3072 sc1
    s_add_u32 s32, s32, 4096
    s_waitcnt vmcnt(14) lgkmcnt(6)
    v_mfma_f32_32x32x16_bf16 v[128:143], v[184:187], v[36:39], v[128:143]
    v_and_b32 v249, 0xffff0000, v10
    v_add_f32 v249, v249, v9
    v_mov_b32 v250, 0
    v_mov_b32 v251, 0
    v_cvt_pk_bf16_f32 v249, -v249, -v249
    v_mfma_f32_32x32x16_bf16 v[144:159], v[36:39], v[188:191], v[144:159]
    ds_read_b128 v[184:187], v1 offset:38912
    ds_read_b128 v[188:191], v2 offset:3072
    buffer_load_dwordx4 v[96:99], v1, s[4:7], s32 offen sc1
    s_waitcnt vmcnt(14) lgkmcnt(6)
    v_mfma_f32_32x32x16_bf16 v[128:143], v[192:195], v[40:43], v[128:143]
    v_cndmask_b32 v248, v10, v250, s[26:27]
    v_cndmask_b32 v249, v249, v250, s[26:27]
    v_rsq_f32 v8, v8
    v_lshrrev_b32 v9, 1, v4
    s_lshl_b32 s20, s14, 7
    s_add_u32 s20, s20, 152576
    v_mfma_f32_32x32x16_bf16 v[144:159], v[40:43], v[196:199], v[144:159]
    ds_read_b128 v[192:195], v1 offset:39936
    ds_read_b128 v[196:199], v2 offset:4096
    buffer_load_dwordx4 v[100:103], v1, s[4:7], s32 offen offset:1024 sc1
    s_waitcnt vmcnt(14) lgkmcnt(6)
    v_mfma_f32_32x32x16_bf16 v[128:143], v[200:203], v[44:47], v[128:143]
    v_add_u32 v9, s20, v9
    ds_write_b32 v9, v8
    v_mul_f32 v6, 0x3fb8aa3b, v8
    v_lshrrev_b32 v9, 5, v1
    v_mfma_f32_32x32x16_bf16 v[144:159], v[44:47], v[204:207], v[144:159]
    ds_read_b128 v[200:203], v1 offset:40960
    ds_read_b128 v[204:207], v2 offset:5120
    buffer_load_dwordx4 v[104:107], v1, s[4:7], s32 offen offset:2048 sc1
    s_waitcnt vmcnt(14) lgkmcnt(7)
    v_mfma_f32_32x32x16_bf16 v[128:143], v[176:179], v[48:51], v[128:143]
    v_and_b32 v9, 16, v9
    v_add_u32 v9, s20, v9
    s_waitcnt lgkmcnt(2)
    ds_read_b128 v[160:163], v9 offset:0
    v_mfma_f32_32x32x16_bf16 v[144:159], v[48:51], v[180:183], v[144:159]
    ds_read_b128 v[176:179], v1 offset:41984
    ds_read_b128 v[180:183], v2 offset:6144
    buffer_load_dwordx4 v[108:111], v1, s[4:7], s32 offen offset:3072 sc1
    s_add_u32 s32, s32, 4096
    s_waitcnt vmcnt(14)
    v_mfma_f32_32x32x16_bf16 v[128:143], v[184:187], v[52:55], v[128:143]
    ds_read_b128 v[164:167], v9 offset:32
    ds_read_b128 v[168:171], v9 offset:64
    v_mfma_f32_32x32x16_bf16 v[144:159], v[52:55], v[188:191], v[144:159]
    ds_read_b128 v[184:187], v1 offset:43008
    ds_read_b128 v[188:191], v2 offset:7168
    buffer_load_dwordx4 v[112:115], v1, s[4:7], s32 offen sc1
    s_waitcnt vmcnt(14)
    v_mfma_f32_32x32x16_bf16 v[128:143], v[192:195], v[56:59], v[128:143]
    ds_read_b128 v[172:175], v9 offset:96
    v_mfma_f32_32x32x16_bf16 v[144:159], v[56:59], v[196:199], v[144:159]
    ds_read_b128 v[192:195], v1 offset:44032
    ds_read_b128 v[196:199], v2 offset:8192
    buffer_load_dwordx4 v[116:119], v1, s[4:7], s32 offen offset:1024 sc1
    s_waitcnt vmcnt(14) lgkmcnt(10)
    v_mfma_f32_32x32x16_bf16 v[128:143], v[200:203], v[60:63], v[128:143]
    v_mfma_f32_32x32x16_bf16 v[144:159], v[60:63], v[204:207], v[144:159]
    ds_read_b128 v[200:203], v1 offset:45056
    ds_read_b128 v[204:207], v2 offset:9216
    buffer_load_dwordx4 v[120:123], v1, s[4:7], s32 offen offset:2048 sc1
    s_waitcnt vmcnt(14) lgkmcnt(9)
    v_mfma_f32_32x32x16_bf16 v[128:143], v[176:179], v[64:67], v[128:143]
    v_mfma_f32_32x32x16_bf16 v[144:159], v[64:67], v[180:183], v[144:159]
    ds_read_b128 v[176:179], v1 offset:46080
    ds_read_b128 v[180:183], v2 offset:10240
    buffer_load_dwordx4 v[124:127], v1, s[4:7], s32 offen offset:3072 sc1
    s_waitcnt vmcnt(14) lgkmcnt(7)
    v_mfma_f32_32x32x16_bf16 v[128:143], v[184:187], v[68:71], v[128:143]
    v_mfma_f32_32x32x16_bf16 v[144:159], v[68:71], v[188:191], v[144:159]
    ds_read_b128 v[184:187], v1 offset:47104
    ds_read_b128 v[188:191], v2 offset:11264
    s_mul_i32 s45, s14, 7168
    s_mul_i32 s44, s13, 89088
    s_mul_i32 s23, s14, 7168
    s_add_u32 s44, s44, s23
    s_mov_b32 m0, s45
    s_nop 0
    buffer_load_dwordx4 v1, s[4:7], s44 offen lds
    s_waitcnt vmcnt(14) lgkmcnt(6)
    v_mfma_f32_32x32x16_bf16 v[128:143], v[192:195], v[72:75], v[128:143]
    v_mfma_f32_32x32x16_bf16 v[144:159], v[72:75], v[196:199], v[144:159]
    ds_read_b128 v[192:195], v1 offset:48128
    ds_read_b128 v[196:199], v2 offset:12288
    buffer_load_dwordx4 v1, s[4:7], s44 offen offset:1024 lds
    s_waitcnt vmcnt(14) lgkmcnt(6)
    v_mfma_f32_32x32x16_bf16 v[128:143], v[200:203], v[76:79], v[128:143]
    v_mfma_f32_32x32x16_bf16 v[144:159], v[76:79], v[204:207], v[144:159]
    ds_read_b128 v[200:203], v1 offset:49152
    ds_read_b128 v[204:207], v2 offset:13312
    buffer_load_dwordx4 v1, s[4:7], s44 offen offset:2048 lds
    s_waitcnt vmcnt(14) lgkmcnt(6)
    v_mfma_f32_32x32x16_bf16 v[128:143], v[176:179], v[80:83], v[128:143]
    v_mfma_f32_32x32x16_bf16 v[144:159], v[80:83], v[180:183], v[144:159]
    ds_read_b128 v[176:179], v1 offset:50176
    ds_read_b128 v[180:183], v2 offset:14336
    buffer_load_dwordx4 v1, s[4:7], s44 offen offset:3072 lds
    s_add_u32 s44, s44, 4096
    s_add_u32 s45, s45, 4096
    s_waitcnt vmcnt(14) lgkmcnt(6)
    v_mfma_f32_32x32x16_bf16 v[128:143], v[184:187], v[84:87], v[128:143]
    v_mfma_f32_32x32x16_bf16 v[144:159], v[84:87], v[188:191], v[144:159]
    ds_read_b128 v[184:187], v1 offset:51200
    ds_read_b128 v[188:191], v2 offset:15360
    s_mov_b32 m0, s45
    s_nop 0
    buffer_load_dwordx4 v1, s[4:7], s44 offen lds
    s_waitcnt vmcnt(14) lgkmcnt(6)
    v_mfma_f32_32x32x16_bf16 v[128:143], v[192:195], v[88:91], v[128:143]
    v_mfma_f32_32x32x16_bf16 v[144:159], v[88:91], v[196:199], v[144:159]
    ds_read_b128 v[192:195], v1 offset:52224
    ds_read_b128 v[196:199], v2 offset:16384
    buffer_load_dwordx4 v1, s[4:7], s44 offen offset:1024 lds
    s_waitcnt vmcnt(14) lgkmcnt(6)
    v_mfma_f32_32x32x16_bf16 v[128:143], v[200:203], v[92:95], v[128:143]
    v_mfma_f32_32x32x16_bf16 v[144:159], v[92:95], v[204:207], v[144:159]
    ds_read_b128 v[200:203], v1 offset:53248
    ds_read_b128 v[204:207], v2 offset:17408
    buffer_load_dwordx4 v1, s[4:7], s44 offen offset:2048 lds
    s_waitcnt vmcnt(14) lgkmcnt(6)
    v_mfma_f32_32x32x16_bf16 v[128:143], v[176:179], v[96:99], v[128:143]
    v_mfma_f32_32x32x16_bf16 v[144:159], v[96:99], v[180:183], v[144:159]
    ds_read_b128 v[176:179], v1 offset:54272
    ds_read_b128 v[180:183], v2 offset:18432
    buffer_load_dwordx4 v1, s[4:7], s44 offen offset:3072 lds
    s_waitcnt vmcnt(14) lgkmcnt(6)
    v_mfma_f32_32x32x16_bf16 v[128:143], v[184:187], v[100:103], v[128:143]
    v_mfma_f32_32x32x16_bf16 v[144:159], v[100:103], v[188:191], v[144:159]
    ds_read_b128 v[184:187], v1 offset:55296
    ds_read_b128 v[188:191], v2 offset:19456
    s_waitcnt vmcnt(13) lgkmcnt(6)
    v_mfma_f32_32x32x16_bf16 v[128:143], v[192:195], v[104:107], v[128:143]
    v_mfma_f32_32x32x16_bf16 v[144:159], v[104:107], v[196:199], v[144:159]
    ds_read_b128 v[192:195], v1 offset:56320
    ds_read_b128 v[196:199], v2 offset:20480
    s_waitcnt vmcnt(12) lgkmcnt(6)
    v_mfma_f32_32x32x16_bf16 v[128:143], v[200:203], v[108:111], v[128:143]
    v_mfma_f32_32x32x16_bf16 v[144:159], v[108:111], v[204:207], v[144:159]
    ds_read_b128 v[200:203], v1 offset:57344
    ds_read_b128 v[204:207], v2 offset:21504
    s_waitcnt vmcnt(11) lgkmcnt(6)
    v_mfma_f32_32x32x16_bf16 v[128:143], v[176:179], v[112:115], v[128:143]
    v_mfma_f32_32x32x16_bf16 v[144:159], v[112:115], v[180:183], v[144:159]
    ds_read_b128 v[176:179], v1 offset:58368
    ds_read_b128 v[180:183], v2 offset:22528
    s_waitcnt vmcnt(10) lgkmcnt(6)
    v_mfma_f32_32x32x16_bf16 v[128:143], v[184:187], v[116:119], v[128:143]
    v_mfma_f32_32x32x16_bf16 v[144:159], v[116:119], v[188:191], v[144:159]
    s_waitcnt vmcnt(9) lgkmcnt(4)
    v_mfma_f32_32x32x16_bf16 v[128:143], v[192:195], v[120:123], v[128:143]
    v_mfma_f32_32x32x16_bf16 v[144:159], v[120:123], v[196:199], v[144:159]
    s_waitcnt vmcnt(8) lgkmcnt(2)
    v_mfma_f32_32x32x16_bf16 v[128:143], v[200:203], v[124:127], v[128:143]
    v_mfma_f32_32x32x16_bf16 v[144:159], v[124:127], v[204:207], v[144:159]
    s_waitcnt lgkmcnt(0)
    v_mfma_f32_32x32x16_bf16 v[128:143], v[176:179], v[248:251], v[128:143]
    v_mfma_f32_32x32x16_bf16 v[144:159], v[248:251], v[180:183], v[144:159]
    s_mul_i32 s40, s29, 237568
    s_mul_i32 s23, s14, 59392
    s_add_u32 s40, s40, s23
    s_add_u32 s40, s40, 1916928
    s_add_u32 s41, s40, 29696
    buffer_load_dwordx4 a[0:3], v1, s[4:7], s40 offen
    buffer_load_dwordx4 a[4:7], v1, s[4:7], s41 offen
    buffer_load_dwordx4 a[8:11], v1, s[4:7], s40 offen offset:1024
    buffer_load_dwordx4 a[12:15], v1, s[4:7], s41 offen offset:1024
    s_nop 1
    v_cvt_pk_bf16_f32 v240, v128, v129
    v_cvt_pk_bf16_f32 v241, v130, v131
    v_cvt_pk_bf16_f32 v242, v132, v133
    v_cvt_pk_bf16_f32 v243, v134, v135
    v_cvt_pk_bf16_f32 v244, v136, v137
    v_cvt_pk_bf16_f32 v245, v138, v139
    v_cvt_pk_bf16_f32 v246, v140, v141
    v_cvt_pk_bf16_f32 v247, v142, v143
    v_mfma_f32_32x32x16_bf16 v[128:143], a[232:235], v[240:243], 0
    s_nop 0
    v_mfma_f32_32x32x16_bf16 v[128:143], a[236:239], v[244:247], v[128:143]
    v_pk_fma_f32 v[144:145], v[144:145], v[160:161], v[4:5] op_sel:[0,0,1] op_sel_hi:[1,1,1]
    v_pk_fma_f32 v[146:147], v[146:147], v[162:163], v[4:5] op_sel:[0,0,1] op_sel_hi:[1,1,1]
    v_pk_fma_f32 v[148:149], v[148:149], v[164:165], v[4:5] op_sel:[0,0,1] op_sel_hi:[1,1,1]
    v_pk_fma_f32 v[150:151], v[150:151], v[166:167], v[4:5] op_sel:[0,0,1] op_sel_hi:[1,1,1]
    v_pk_fma_f32 v[152:153], v[152:153], v[168:169], v[4:5] op_sel:[0,0,1] op_sel_hi:[1,1,1]
    v_pk_fma_f32 v[154:155], v[154:155], v[170:171], v[4:5] op_sel:[0,0,1] op_sel_hi:[1,1,1]
    v_pk_fma_f32 v[156:157], v[156:157], v[172:173], v[4:5] op_sel:[0,0,1] op_sel_hi:[1,1,1]
    v_pk_fma_f32 v[158:159], v[158:159], v[174:175], v[4:5] op_sel:[0,0,1] op_sel_hi:[1,1,1]
    v_cvt_pk_bf16_f32 v144, v144, v145
    v_cvt_pk_bf16_f32 v145, v146, v147
    v_cvt_pk_bf16_f32 v146, v148, v149
    v_cvt_pk_bf16_f32 v147, v150, v151
    v_cvt_pk_bf16_f32 v148, v152, v153
    v_cvt_pk_bf16_f32 v149, v154, v155
    v_cvt_pk_bf16_f32 v150, v156, v157
    v_cvt_pk_bf16_f32 v151, v158, v159
    buffer_load_dwordx4 a[16:19], v1, s[4:7], s40 offen offset:2048
    v_max3_f32 v8, v128, v129, v130
    v_min3_f32 v9, v128, v129, v130
    v_max3_f32 v10, v131, v132, v133
    v_min3_f32 v11, v131, v132, v133
    v_max3_f32 v8, v8, v134, v135
    v_min3_f32 v9, v9, v134, v135
    buffer_load_dwordx4 a[20:23], v1, s[4:7], s41 offen offset:2048
    v_max3_f32 v10, v10, v136, v137
    v_min3_f32 v11, v11, v136, v137
    v_max3_f32 v8, v8, v138, v139
    v_min3_f32 v9, v9, v138, v139
    v_max3_f32 v10, v10, v140, v141
    v_min3_f32 v11, v11, v140, v141
    buffer_load_dwordx4 a[24:27], v1, s[4:7], s40 offen offset:3072
    s_add_u32 s40, s40, 4096
    v_max3_f32 v8, v8, v142, v143
    v_min3_f32 v9, v9, v142, v143
    v_max_f32 v8, v8, v10
    v_min_f32 v9, v9, v11
    v_mov_b32 v10, v8
    v_mov_b32 v11, v9
    buffer_load_dwordx4 a[28:31], v1, s[4:7], s41 offen offset:3072
    s_add_u32 s41, s41, 4096
    v_mov_b32 v14, 0x7149f2ca
    v_mov_b32 v15, 0xf149f2ca
    v_permlane32_swap_b32 v10, v8
    v_permlane32_swap_b32 v11, v9
    v_max_f32 v8, v8, v10
    v_min_f32 v9, v9, v11
    buffer_load_dwordx4 a[32:35], v1, s[4:7], s40 offen
    v_mul_f32 v12, v6, v8
    v_mul_f32 v13, v6, v9
    v_cndmask_b32 v14, v12, v14, s[26:27]
    v_cndmask_b32 v15, v13, v15, s[26:27]
    v_pk_fma_f32 v[208:209], v[128:129], v[6:7], v[12:13] op_sel:[0,0,0] op_sel_hi:[1,0,0] neg_lo:[0,0,1] neg_hi:[0,0,1]
    v_pk_fma_f32 v[210:211], v[130:131], v[6:7], v[12:13] op_sel:[0,0,0] op_sel_hi:[1,0,0] neg_lo:[0,0,1] neg_hi:[0,0,1]
    buffer_load_dwordx4 a[36:39], v1, s[4:7], s41 offen
    v_pk_fma_f32 v[128:129], v[128:129], v[6:7], v[12:13] op_sel:[0,0,1] op_sel_hi:[1,0,1] neg_lo:[1,0,0] neg_hi:[1,0,0]
    v_pk_fma_f32 v[130:131], v[130:131], v[6:7], v[12:13] op_sel:[0,0,1] op_sel_hi:[1,0,1] neg_lo:[1,0,0] neg_hi:[1,0,0]
    v_pk_fma_f32 v[212:213], v[132:133], v[6:7], v[12:13] op_sel:[0,0,0] op_sel_hi:[1,0,0] neg_lo:[0,0,1] neg_hi:[0,0,1]
    v_pk_fma_f32 v[214:215], v[134:135], v[6:7], v[12:13] op_sel:[0,0,0] op_sel_hi:[1,0,0] neg_lo:[0,0,1] neg_hi:[0,0,1]
    v_pk_fma_f32 v[132:133], v[132:133], v[6:7], v[12:13] op_sel:[0,0,1] op_sel_hi:[1,0,1] neg_lo:[1,0,0] neg_hi:[1,0,0]
    v_pk_fma_f32 v[134:135], v[134:135], v[6:7], v[12:13] op_sel:[0,0,1] op_sel_hi:[1,0,1] neg_lo:[1,0,0] neg_hi:[1,0,0]
    buffer_load_dwordx4 a[40:43], v1, s[4:7], s40 offen offset:1024
    v_pk_fma_f32 v[216:217], v[136:137], v[6:7], v[12:13] op_sel:[0,0,0] op_sel_hi:[1,0,0] neg_lo:[0,0,1] neg_hi:[0,0,1]
    v_pk_fma_f32 v[218:219], v[138:139], v[6:7], v[12:13] op_sel:[0,0,0] op_sel_hi:[1,0,0] neg_lo:[0,0,1] neg_hi:[0,0,1]
    v_pk_fma_f32 v[136:137], v[136:137], v[6:7], v[12:13] op_sel:[0,0,1] op_sel_hi:[1,0,1] neg_lo:[1,0,0] neg_hi:[1,0,0]
    v_pk_fma_f32 v[138:139], v[138:139], v[6:7], v[12:13] op_sel:[0,0,1] op_sel_hi:[1,0,1] neg_lo:[1,0,0] neg_hi:[1,0,0]
    v_pk_fma_f32 v[220:221], v[140:141], v[6:7], v[14:15] op_sel:[0,0,0] op_sel_hi:[1,0,0] neg_lo:[0,0,1] neg_hi:[0,0,1]
    v_pk_fma_f32 v[222:223], v[142:143], v[6:7], v[14:15] op_sel:[0,0,0] op_sel_hi:[1,0,0] neg_lo:[0,0,1] neg_hi:[0,0,1]
    buffer_load_dwordx4 a[44:47], v1, s[4:7], s41 offen offset:1024
    v_pk_fma_f32 v[140:141], v[140:141], v[6:7], v[14:15] op_sel:[0,0,1] op_sel_hi:[1,0,1] neg_lo:[1,0,0] neg_hi:[1,0,0]
    v_pk_fma_f32 v[142:143], v[142:143], v[6:7], v[14:15] op_sel:[0,0,1] op_sel_hi:[1,0,1] neg_lo:[1,0,0] neg_hi:[1,0,0]
    v_exp_f32 v208, v208
    v_exp_f32 v209, v209
    v_exp_f32 v210, v210
    v_exp_f32 v211, v211
    buffer_load_dwordx4 a[48:51], v1, s[4:7], s40 offen offset:2048
    v_exp_f32 v128, v128
    v_exp_f32 v129, v129
    v_exp_f32 v130, v130
    v_exp_f32 v131, v131
    v_exp_f32 v212, v212
    v_exp_f32 v213, v213
    buffer_load_dwordx4 a[52:55], v1, s[4:7], s41 offen offset:2048
    v_exp_f32 v214, v214
    v_exp_f32 v215, v215
    v_exp_f32 v132, v132
    v_exp_f32 v133, v133
    v_exp_f32 v134, v134
    v_exp_f32 v135, v135
    buffer_load_dwordx4 a[56:59], v1, s[4:7], s40 offen offset:3072
    s_add_u32 s40, s40, 4096
    v_pk_add_f32 v[8:9], v[208:209], v[210:211]
    v_pk_add_f32 v[10:11], v[128:129], v[130:131]
    v_exp_f32 v216, v216
    v_exp_f32 v217, v217
    v_exp_f32 v218, v218
    v_exp_f32 v219, v219
    buffer_load_dwordx4 a[60:63], v1, s[4:7], s41 offen offset:3072
    s_add_u32 s41, s41, 4096
    v_exp_f32 v136, v136
    v_exp_f32 v137, v137
    v_exp_f32 v138, v138
    v_exp_f32 v139, v139
    v_pk_add_f32 v[8:9], v[8:9], v[212:213]
    v_pk_add_f32 v[10:11], v[10:11], v[132:133]
    buffer_load_dwordx4 a[64:67], v1, s[4:7], s40 offen
    v_pk_add_f32 v[8:9], v[8:9], v[214:215]
    v_pk_add_f32 v[10:11], v[10:11], v[134:135]
    v_exp_f32 v220, v220
    v_exp_f32 v221, v221
    v_exp_f32 v222, v222
    v_exp_f32 v223, v223
    v_exp_f32 v140, v140
    v_exp_f32 v141, v141
    v_exp_f32 v142, v142
    v_exp_f32 v143, v143
    v_pk_add_f32 v[8:9], v[8:9], v[216:217]
    v_pk_add_f32 v[10:11], v[10:11], v[136:137]
    v_pk_add_f32 v[8:9], v[8:9], v[218:219]
    v_pk_add_f32 v[10:11], v[10:11], v[138:139]
    v_pk_add_f32 v[8:9], v[8:9], v[220:221]
    v_pk_add_f32 v[10:11], v[10:11], v[140:141]
    v_pk_add_f32 v[8:9], v[8:9], v[222:223]
    v_pk_add_f32 v[10:11], v[10:11], v[142:143]
    v_add_f32 v8, v8, v9
    v_add_f32 v10, v10, v11
    v_mov_b32 v9, v8
    v_mov_b32 v11, v10
    s_nop 0
    v_permlane32_swap_b32 v9, v8
    v_permlane32_swap_b32 v11, v10
    v_add_f32 v8, v8, v9
    v_add_f32 v10, v10, v11
    v_rcp_f32 v8, v8
    v_rcp_f32 v10, v10
    v_pk_mul_f32 v[208:209], v[208:209], v[8:9] op_sel:[0,0] op_sel_hi:[1,0]
    v_pk_mul_f32 v[210:211], v[210:211], v[8:9] op_sel:[0,0] op_sel_hi:[1,0]
    v_pk_mul_f32 v[212:213], v[212:213], v[8:9] op_sel:[0,0] op_sel_hi:[1,0]
    v_pk_mul_f32 v[214:215], v[214:215], v[8:9] op_sel:[0,0] op_sel_hi:[1,0]
    v_pk_mul_f32 v[216:217], v[216:217], v[8:9] op_sel:[0,0] op_sel_hi:[1,0]
    v_pk_mul_f32 v[218:219], v[218:219], v[8:9] op_sel:[0,0] op_sel_hi:[1,0]
    v_pk_mul_f32 v[220:221], v[220:221], v[8:9] op_sel:[0,0] op_sel_hi:[1,0]
    v_pk_mul_f32 v[222:223], v[222:223], v[8:9] op_sel:[0,0] op_sel_hi:[1,0]
    v_pk_mul_f32 v[128:129], v[128:129], v[10:11] op_sel:[0,0] op_sel_hi:[1,0]
    v_pk_mul_f32 v[130:131], v[130:131], v[10:11] op_sel:[0,0] op_sel_hi:[1,0]
    v_pk_mul_f32 v[132:133], v[132:133], v[10:11] op_sel:[0,0] op_sel_hi:[1,0]
    v_pk_mul_f32 v[134:135], v[134:135], v[10:11] op_sel:[0,0] op_sel_hi:[1,0]
    v_pk_mul_f32 v[136:137], v[136:137], v[10:11] op_sel:[0,0] op_sel_hi:[1,0]
    v_pk_mul_f32 v[138:139], v[138:139], v[10:11] op_sel:[0,0] op_sel_hi:[1,0]
    v_pk_mul_f32 v[140:141], v[140:141], v[10:11] op_sel:[0,0] op_sel_hi:[1,0]
    v_pk_mul_f32 v[142:143], v[142:143], v[10:11] op_sel:[0,0] op_sel_hi:[1,0]
    v_cvt_pk_bf16_f32 v208, v208, v209
    v_cvt_pk_bf16_f32 v209, v210, v211
    v_cvt_pk_bf16_f32 v210, v212, v213
    v_cvt_pk_bf16_f32 v211, v214, v215
    v_cvt_pk_bf16_f32 v212, v216, v217
    v_cvt_pk_bf16_f32 v213, v218, v219
    v_cvt_pk_bf16_f32 v214, v220, v221
    v_cvt_pk_bf16_f32 v215, v222, v223
    v_cvt_pk_bf16_f32 v128, v128, v129
    v_cvt_pk_bf16_f32 v129, v130, v131
    v_cvt_pk_bf16_f32 v130, v132, v133
    v_cvt_pk_bf16_f32 v131, v134, v135
    v_cvt_pk_bf16_f32 v132, v136, v137
    v_cvt_pk_bf16_f32 v133, v138, v139
    v_cvt_pk_bf16_f32 v134, v140, v141
    v_cvt_pk_bf16_f32 v135, v142, v143
    v_mfma_f32_32x32x16_bf16 v[224:239], v[208:211], a[240:243], 0
    v_mfma_f32_32x32x16_bf16 v[224:239], v[212:215], a[244:247], v[224:239]
    v_mfma_f32_32x32x16_bf16 v[208:223], v[128:131], a[240:243], 0
    v_mfma_f32_32x32x16_bf16 v[208:223], v[132:135], a[244:247], v[208:223]
    s_lshl_b32 s20, s14, 11
    s_add_u32 s20, s20, 89088
    v_add_u32 v8, s20, v1
    s_lshl_b32 s20, s14, 13
    s_add_u32 s20, s20, 89088
    v_add_u32 v9, s20, v1
    s_lshl_b32 s34, s13, 16
    s_lshl_b32 s23, s14, 14
    s_add_u32 s34, s34, s23
    s_lshl_b32 s23, s15, 20
    s_add_u32 s34, s34, s23
    s_add_u32 s34, s34, 15106048
    v_cvt_pk_bf16_f32 v224, v224, v225
    v_cvt_pk_bf16_f32 v225, v226, v227
    v_cvt_pk_bf16_f32 v226, v228, v229
    v_cvt_pk_bf16_f32 v227, v230, v231
    v_cvt_pk_bf16_f32 v228, v232, v233
    v_cvt_pk_bf16_f32 v229, v234, v235
    v_cvt_pk_bf16_f32 v230, v236, v237
    v_cvt_pk_bf16_f32 v231, v238, v239
    v_mfma_f32_32x32x16_bf16 v[128:143], v[224:227], v[144:147], 0
    s_nop 0
    v_mfma_f32_32x32x16_bf16 v[128:143], v[228:231], v[148:151], v[128:143]
    v_cvt_pk_bf16_f32 v208, v208, v209
    v_cvt_pk_bf16_f32 v209, v210, v211
    v_cvt_pk_bf16_f32 v210, v212, v213
    v_cvt_pk_bf16_f32 v211, v214, v215
    v_cvt_pk_bf16_f32 v212, v216, v217
    v_cvt_pk_bf16_f32 v213, v218, v219
    v_cvt_pk_bf16_f32 v214, v220, v221
    v_cvt_pk_bf16_f32 v215, v222, v223
    v_mfma_f32_32x32x16_bf16 v[224:239], v[208:211], v[144:147], 0
    s_nop 0
    v_mfma_f32_32x32x16_bf16 v[224:239], v[212:215], v[148:151], v[224:239]
    s_lshl_b32 s35, s12, 10
    s_add_u32 s35, s35, s34
    ds_write_b128 v8, v[128:131] offset:0
    ds_write_b128 v8, v[132:135] offset:1024
    ds_write_b128 v8, v[136:139] offset:8192
    ds_write_b128 v8, v[140:143] offset:9216
    s_nop 5
    ds_write_b128 v8, v[224:227] offset:16384
    ds_write_b128 v8, v[228:231] offset:17408
    ds_write_b128 v8, v[232:235] offset:24576
    ds_write_b128 v8, v[236:239] offset:25600
    s_waitcnt vmcnt(17)
    s_waitcnt lgkmcnt(0)
    s_barrier
    ds_read_b128 v[176:179], v9 offset:0
    ds_read_b128 v[180:183], v9 offset:1024
    ds_read_b128 v[184:187], v9 offset:2048
    ds_read_b128 v[188:191], v9 offset:3072
    ds_read_b128 v[192:195], v9 offset:4096
    ds_read_b128 v[196:199], v9 offset:5120
    ds_read_b128 v[200:203], v9 offset:6144
    ds_read_b128 v[204:207], v9 offset:7168
    s_waitcnt lgkmcnt(4)
    v_pk_add_f32 v[176:177], v[176:177], v[184:185]
    v_pk_add_f32 v[178:179], v[178:179], v[186:187]
    v_pk_add_f32 v[180:181], v[180:181], v[188:189]
    v_pk_add_f32 v[182:183], v[182:183], v[190:191]
    s_waitcnt lgkmcnt(0)
    v_pk_add_f32 v[192:193], v[192:193], v[200:201]
    v_pk_add_f32 v[194:195], v[194:195], v[202:203]
    v_pk_add_f32 v[196:197], v[196:197], v[204:205]
    v_pk_add_f32 v[198:199], v[198:199], v[206:207]
    v_pk_add_f32 v[176:177], v[176:177], v[192:193]
    v_pk_add_f32 v[178:179], v[178:179], v[194:195]
    v_pk_add_f32 v[180:181], v[180:181], v[196:197]
    v_pk_add_f32 v[182:183], v[182:183], v[198:199]
    v_cvt_pk_bf16_f32 v176, v176, v177
    v_cvt_pk_bf16_f32 v177, v178, v179
    v_cvt_pk_bf16_f32 v178, v180, v181
    v_cvt_pk_bf16_f32 v179, v182, v183
    buffer_store_dwordx4 v[176:179], v1, s[4:7], s35 offen sc1
    ds_read_b128 v[208:211], v1 offset:0
    ds_read_b128 v[212:215], v1 offset:1024
    ds_read_b128 v[216:219], v1 offset:2048
    ds_read_b128 v[220:223], v1 offset:3072
    s_waitcnt lgkmcnt(3)
    v_mfma_f32_32x32x16_bf16 v[160:175], v[208:211], v[16:19], 0
    buffer_load_dwordx4 a[68:71], v1, s[4:7], s41 offen
    ds_read_b128 v[208:211], v1 offset:4096
    s_waitcnt lgkmcnt(3)
    v_mfma_f32_32x32x16_bf16 v[160:175], v[212:215], v[20:23], v[160:175]
    ds_read_b128 v[212:215], v1 offset:5120
    s_waitcnt lgkmcnt(3)
    v_mfma_f32_32x32x16_bf16 v[160:175], v[216:219], v[24:27], v[160:175]
    buffer_load_dwordx4 a[72:75], v1, s[4:7], s40 offen offset:1024
    ds_read_b128 v[216:219], v1 offset:6144
    s_waitcnt lgkmcnt(3)
    v_mfma_f32_32x32x16_bf16 v[160:175], v[220:223], v[28:31], v[160:175]
    ds_read_b128 v[220:223], v1 offset:7168
    s_waitcnt lgkmcnt(3)
    v_mfma_f32_32x32x16_bf16 v[160:175], v[208:211], v[32:35], v[160:175]
    buffer_load_dwordx4 a[76:79], v1, s[4:7], s41 offen offset:1024
    ds_read_b128 v[208:211], v1 offset:8192
    s_waitcnt lgkmcnt(3)
    v_mfma_f32_32x32x16_bf16 v[160:175], v[212:215], v[36:39], v[160:175]
    ds_read_b128 v[212:215], v1 offset:9216
    s_waitcnt lgkmcnt(3)
    v_mfma_f32_32x32x16_bf16 v[160:175], v[216:219], v[40:43], v[160:175]
    buffer_load_dwordx4 a[80:83], v1, s[4:7], s40 offen offset:2048
    ds_read_b128 v[216:219], v1 offset:10240
    s_waitcnt lgkmcnt(3)
    v_mfma_f32_32x32x16_bf16 v[160:175], v[220:223], v[44:47], v[160:175]
    ds_read_b128 v[220:223], v1 offset:11264
    s_waitcnt lgkmcnt(3)
    v_mfma_f32_32x32x16_bf16 v[160:175], v[208:211], v[48:51], v[160:175]
    buffer_load_dwordx4 a[84:87], v1, s[4:7], s41 offen offset:2048
    ds_read_b128 v[208:211], v1 offset:12288
    s_waitcnt lgkmcnt(3)
    v_mfma_f32_32x32x16_bf16 v[160:175], v[212:215], v[52:55], v[160:175]
    ds_read_b128 v[212:215], v1 offset:13312
    s_waitcnt lgkmcnt(3)
    v_mfma_f32_32x32x16_bf16 v[160:175], v[216:219], v[56:59], v[160:175]
    buffer_load_dwordx4 a[88:91], v1, s[4:7], s40 offen offset:3072
    s_add_u32 s40, s40, 4096
    ds_read_b128 v[216:219], v1 offset:14336
    s_waitcnt lgkmcnt(3)
    v_mfma_f32_32x32x16_bf16 v[160:175], v[220:223], v[60:63], v[160:175]
    ds_read_b128 v[220:223], v1 offset:15360
    s_waitcnt lgkmcnt(3)
    v_mfma_f32_32x32x16_bf16 v[160:175], v[208:211], v[64:67], v[160:175]
    buffer_load_dwordx4 a[92:95], v1, s[4:7], s41 offen offset:3072
    s_add_u32 s41, s41, 4096
    ds_read_b128 v[208:211], v1 offset:16384
    s_waitcnt lgkmcnt(3)
    v_mfma_f32_32x32x16_bf16 v[160:175], v[212:215], v[68:71], v[160:175]
    ds_read_b128 v[212:215], v1 offset:17408
    s_waitcnt lgkmcnt(3)
    v_mfma_f32_32x32x16_bf16 v[160:175], v[216:219], v[72:75], v[160:175]
    buffer_load_dwordx4 a[96:99], v1, s[4:7], s40 offen
    ds_read_b128 v[216:219], v1 offset:18432
    s_waitcnt lgkmcnt(3)
    v_mfma_f32_32x32x16_bf16 v[160:175], v[220:223], v[76:79], v[160:175]
    ds_read_b128 v[220:223], v1 offset:19456
    s_waitcnt lgkmcnt(3)
    v_mfma_f32_32x32x16_bf16 v[160:175], v[208:211], v[80:83], v[160:175]
    buffer_load_dwordx4 a[100:103], v1, s[4:7], s41 offen
    ds_read_b128 v[208:211], v1 offset:20480
    s_waitcnt lgkmcnt(3)
    v_mfma_f32_32x32x16_bf16 v[160:175], v[212:215], v[84:87], v[160:175]
    ds_read_b128 v[212:215], v1 offset:21504
    s_waitcnt lgkmcnt(3)
    v_mfma_f32_32x32x16_bf16 v[160:175], v[216:219], v[88:91], v[160:175]
    buffer_load_dwordx4 a[104:107], v1, s[4:7], s40 offen offset:1024
    ds_read_b128 v[216:219], v1 offset:22528
    s_waitcnt lgkmcnt(3)
    v_mfma_f32_32x32x16_bf16 v[160:175], v[220:223], v[92:95], v[160:175]
    s_waitcnt vmcnt(10)
    s_barrier
    s_add_u32 s22, s49, 0
    v_mov_b32 v15, 1
    s_cmp_eq_u32 s14, 0
    s_cselect_b64 exec, 1, 0
    buffer_atomic_add v15, off, s[4:7], s22 sc1
    s_mov_b64 exec, -1
    ds_read_b128 v[220:223], v1 offset:23552
    s_waitcnt lgkmcnt(3)
    v_mfma_f32_32x32x16_bf16 v[160:175], v[208:211], v[96:99], v[160:175]
    buffer_load_dwordx4 a[108:111], v1, s[4:7], s41 offen offset:1024
    ds_read_b128 v[208:211], v1 offset:24576
    s_waitcnt lgkmcnt(3)
    v_mfma_f32_32x32x16_bf16 v[160:175], v[212:215], v[100:103], v[160:175]
    ds_read_b128 v[212:215], v1 offset:25600
    s_waitcnt lgkmcnt(3)
    v_mfma_f32_32x32x16_bf16 v[160:175], v[216:219], v[104:107], v[160:175]
    buffer_load_dwordx4 a[112:115], v1, s[4:7], s40 offen offset:2048
    ds_read_b128 v[216:219], v1 offset:26624
    s_waitcnt lgkmcnt(3)
    v_mfma_f32_32x32x16_bf16 v[160:175], v[220:223], v[108:111], v[160:175]
    ds_read_b128 v[220:223], v1 offset:27648
    s_waitcnt lgkmcnt(3)
    v_mfma_f32_32x32x16_bf16 v[160:175], v[208:211], v[112:115], v[160:175]
    buffer_load_dwordx4 a[116:119], v1, s[4:7], s41 offen offset:2048
    ds_read_b128 v[208:211], v1 offset:28672
    s_waitcnt lgkmcnt(3)
    v_mfma_f32_32x32x16_bf16 v[160:175], v[212:215], v[116:119], v[160:175]
    s_waitcnt lgkmcnt(2)
    v_mfma_f32_32x32x16_bf16 v[160:175], v[216:219], v[120:123], v[160:175]
    buffer_load_dwordx4 a[120:123], v1, s[4:7], s40 offen offset:3072
    s_add_u32 s40, s40, 4096
    s_waitcnt lgkmcnt(1)
    v_mfma_f32_32x32x16_bf16 v[160:175], v[220:223], v[124:127], v[160:175]
    s_waitcnt lgkmcnt(0)
    v_mfma_f32_32x32x16_bf16 v[160:175], v[208:211], v[248:251], v[160:175]
    buffer_load_dwordx4 a[124:127], v1, s[4:7], s41 offen offset:3072
    s_add_u32 s41, s41, 4096
    s_xor_b32 s42, s19, 0
    s_lshl_b32 s42, s42, 15
    s_lshl_b32 s20, s17, 16
    s_lshl_b32 s23, s14, 13
    s_add_u32 s20, s20, s23
    s_add_u32 s20, s20, 1458176
    s_add_u32 s42, s42, s20
    s_xor_b32 s43, s19, 1
    s_lshl_b32 s43, s43, 15
    s_lshl_b32 s20, s17, 16
    s_lshl_b32 s23, s14, 13
    s_add_u32 s20, s20, s23
    s_add_u32 s20, s20, 1458176
    s_add_u32 s43, s43, s20
    buffer_load_dwordx4 v[16:19], v1, s[4:7], s42 offen
    v_cvt_pk_bf16_f32 v240, v160, v161
    v_cvt_pk_bf16_f32 v241, v162, v163
    v_cvt_pk_bf16_f32 v242, v164, v165
    v_cvt_pk_bf16_f32 v243, v166, v167
    v_cvt_pk_bf16_f32 v244, v168, v169
    v_cvt_pk_bf16_f32 v245, v170, v171
    v_cvt_pk_bf16_f32 v246, v172, v173
    v_cvt_pk_bf16_f32 v247, v174, v175
    v_mfma_f32_32x32x16_bf16 v[160:175], a[232:235], v[240:243], 0
    s_nop 0
    v_mfma_f32_32x32x16_bf16 v[160:175], a[236:239], v[244:247], v[160:175]
    s_nop 11
    v_max3_f32 v8, v160, v161, v162
    buffer_load_dwordx4 v[48:51], v1, s[4:7], s43 offen
    v_min3_f32 v9, v160, v161, v162
    v_max3_f32 v10, v163, v164, v165
    v_min3_f32 v11, v163, v164, v165
    v_max3_f32 v8, v8, v166, v167
    v_min3_f32 v9, v9, v166, v167
    v_max3_f32 v10, v10, v168, v169
    v_min3_f32 v11, v11, v168, v169
    v_max3_f32 v8, v8, v170, v171
    v_min3_f32 v9, v9, v170, v171
    v_max3_f32 v10, v10, v172, v173
    v_min3_f32 v11, v11, v172, v173
    buffer_load_dwordx4 v[20:23], v1, s[4:7], s42 offen offset:1024
    v_max3_f32 v8, v8, v174, v175
    v_min3_f32 v9, v9, v174, v175
    v_max_f32 v8, v8, v10
    v_min_f32 v9, v9, v11
    v_mov_b32 v10, v8
    v_mov_b32 v11, v9
    v_mov_b32 v14, 0x7149f2ca
    v_mov_b32 v15, 0xf149f2ca
    v_permlane32_swap_b32 v10, v8
    v_permlane32_swap_b32 v11, v9
    v_max_f32 v8, v8, v10
    buffer_load_dwordx4 v[52:55], v1, s[4:7], s43 offen offset:1024
    v_min_f32 v9, v9, v11
    v_mul_f32 v12, v6, v8
    v_mul_f32 v13, v6, v9
    v_cndmask_b32 v14, v12, v14, s[26:27]
    v_cndmask_b32 v15, v13, v15, s[26:27]
    v_pk_fma_f32 v[208:209], v[160:161], v[6:7], v[12:13] op_sel:[0,0,0] op_sel_hi:[1,0,0] neg_lo:[0,0,1] neg_hi:[0,0,1]
    v_pk_fma_f32 v[210:211], v[162:163], v[6:7], v[12:13] op_sel:[0,0,0] op_sel_hi:[1,0,0] neg_lo:[0,0,1] neg_hi:[0,0,1]
    v_pk_fma_f32 v[160:161], v[160:161], v[6:7], v[12:13] op_sel:[0,0,1] op_sel_hi:[1,0,1] neg_lo:[1,0,0] neg_hi:[1,0,0]
    v_pk_fma_f32 v[162:163], v[162:163], v[6:7], v[12:13] op_sel:[0,0,1] op_sel_hi:[1,0,1] neg_lo:[1,0,0] neg_hi:[1,0,0]
    v_pk_fma_f32 v[212:213], v[164:165], v[6:7], v[12:13] op_sel:[0,0,0] op_sel_hi:[1,0,0] neg_lo:[0,0,1] neg_hi:[0,0,1]
    v_pk_fma_f32 v[214:215], v[166:167], v[6:7], v[12:13] op_sel:[0,0,0] op_sel_hi:[1,0,0] neg_lo:[0,0,1] neg_hi:[0,0,1]
    buffer_load_dwordx4 v[24:27], v1, s[4:7], s42 offen offset:2048
    v_pk_fma_f32 v[164:165], v[164:165], v[6:7], v[12:13] op_sel:[0,0,1] op_sel_hi:[1,0,1] neg_lo:[1,0,0] neg_hi:[1,0,0]
    v_pk_fma_f32 v[166:167], v[166:167], v[6:7], v[12:13] op_sel:[0,0,1] op_sel_hi:[1,0,1] neg_lo:[1,0,0] neg_hi:[1,0,0]
    v_pk_fma_f32 v[216:217], v[168:169], v[6:7], v[12:13] op_sel:[0,0,0] op_sel_hi:[1,0,0] neg_lo:[0,0,1] neg_hi:[0,0,1]
    v_pk_fma_f32 v[218:219], v[170:171], v[6:7], v[12:13] op_sel:[0,0,0] op_sel_hi:[1,0,0] neg_lo:[0,0,1] neg_hi:[0,0,1]
    v_pk_fma_f32 v[168:169], v[168:169], v[6:7], v[12:13] op_sel:[0,0,1] op_sel_hi:[1,0,1] neg_lo:[1,0,0] neg_hi:[1,0,0]
    v_pk_fma_f32 v[170:171], v[170:171], v[6:7], v[12:13] op_sel:[0,0,1] op_sel_hi:[1,0,1] neg_lo:[1,0,0] neg_hi:[1,0,0]
    v_pk_fma_f32 v[220:221], v[172:173], v[6:7], v[14:15] op_sel:[0,0,0] op_sel_hi:[1,0,0] neg_lo:[0,0,1] neg_hi:[0,0,1]
    v_pk_fma_f32 v[222:223], v[174:175], v[6:7], v[14:15] op_sel:[0,0,0] op_sel_hi:[1,0,0] neg_lo:[0,0,1] neg_hi:[0,0,1]
    v_pk_fma_f32 v[172:173], v[172:173], v[6:7], v[14:15] op_sel:[0,0,1] op_sel_hi:[1,0,1] neg_lo:[1,0,0] neg_hi:[1,0,0]
    v_pk_fma_f32 v[174:175], v[174:175], v[6:7], v[14:15] op_sel:[0,0,1] op_sel_hi:[1,0,1] neg_lo:[1,0,0] neg_hi:[1,0,0]
    v_exp_f32 v208, v208
    buffer_load_dwordx4 v[56:59], v1, s[4:7], s43 offen offset:2048
    v_exp_f32 v209, v209
    v_exp_f32 v210, v210
    v_exp_f32 v211, v211
    v_exp_f32 v160, v160
    v_exp_f32 v161, v161
    v_exp_f32 v162, v162
    v_exp_f32 v163, v163
    v_exp_f32 v212, v212
    v_exp_f32 v213, v213
    v_exp_f32 v214, v214
    v_exp_f32 v215, v215
    buffer_load_dwordx4 v[28:31], v1, s[4:7], s42 offen offset:3072
    s_add_u32 s42, s42, 4096
    v_exp_f32 v164, v164
    v_exp_f32 v165, v165
    v_exp_f32 v166, v166
    v_exp_f32 v167, v167
    s_mov_b32 s38, 0
    s_lshl_b32 s39, s38, 11
    s_add_u32 s39, s39, s49
    s_add_u32 s39, s39, 0
    s_mov_b64 exec, 1024
    buffer_load_dword v0, off, s[4:7], s39 sc1
    s_mov_b64 exec, -1
    v_pk_add_f32 v[8:9], v[208:209], v[210:211]
    v_pk_add_f32 v[10:11], v[160:161], v[162:163]
    v_exp_f32 v216, v216
    v_exp_f32 v217, v217
    v_exp_f32 v218, v218
    v_exp_f32 v219, v219
    v_exp_f32 v168, v168
    v_exp_f32 v169, v169
    v_exp_f32 v170, v170
    v_exp_f32 v171, v171
    v_pk_add_f32 v[8:9], v[8:9], v[212:213]
    v_pk_add_f32 v[10:11], v[10:11], v[164:165]
    v_pk_add_f32 v[8:9], v[8:9], v[214:215]
    v_pk_add_f32 v[10:11], v[10:11], v[166:167]
    v_exp_f32 v220, v220
    v_exp_f32 v221, v221
    v_exp_f32 v222, v222
    v_exp_f32 v223, v223
    v_exp_f32 v172, v172
    v_exp_f32 v173, v173
    v_exp_f32 v174, v174
    v_exp_f32 v175, v175
    v_pk_add_f32 v[8:9], v[8:9], v[216:217]
    v_pk_add_f32 v[10:11], v[10:11], v[168:169]
    v_pk_add_f32 v[8:9], v[8:9], v[218:219]
    v_pk_add_f32 v[10:11], v[10:11], v[170:171]
    v_pk_add_f32 v[8:9], v[8:9], v[220:221]
    v_pk_add_f32 v[10:11], v[10:11], v[172:173]
    v_pk_add_f32 v[8:9], v[8:9], v[222:223]
    v_pk_add_f32 v[10:11], v[10:11], v[174:175]
    v_add_f32 v8, v8, v9
    v_add_f32 v10, v10, v11
    v_mov_b32 v9, v8
    v_mov_b32 v11, v10
    s_nop 0
    v_permlane32_swap_b32 v9, v8
    v_permlane32_swap_b32 v11, v10
    v_add_f32 v8, v8, v9
    v_add_f32 v10, v10, v11
    v_rcp_f32 v8, v8
    v_rcp_f32 v10, v10
    v_pk_mul_f32 v[208:209], v[208:209], v[8:9] op_sel:[0,0] op_sel_hi:[1,0]
    v_pk_mul_f32 v[210:211], v[210:211], v[8:9] op_sel:[0,0] op_sel_hi:[1,0]
    v_pk_mul_f32 v[212:213], v[212:213], v[8:9] op_sel:[0,0] op_sel_hi:[1,0]
    v_pk_mul_f32 v[214:215], v[214:215], v[8:9] op_sel:[0,0] op_sel_hi:[1,0]
    v_pk_mul_f32 v[216:217], v[216:217], v[8:9] op_sel:[0,0] op_sel_hi:[1,0]
    v_pk_mul_f32 v[218:219], v[218:219], v[8:9] op_sel:[0,0] op_sel_hi:[1,0]
    v_pk_mul_f32 v[220:221], v[220:221], v[8:9] op_sel:[0,0] op_sel_hi:[1,0]
    v_pk_mul_f32 v[222:223], v[222:223], v[8:9] op_sel:[0,0] op_sel_hi:[1,0]
    v_pk_mul_f32 v[160:161], v[160:161], v[10:11] op_sel:[0,0] op_sel_hi:[1,0]
    v_pk_mul_f32 v[162:163], v[162:163], v[10:11] op_sel:[0,0] op_sel_hi:[1,0]
    v_pk_mul_f32 v[164:165], v[164:165], v[10:11] op_sel:[0,0] op_sel_hi:[1,0]
    v_pk_mul_f32 v[166:167], v[166:167], v[10:11] op_sel:[0,0] op_sel_hi:[1,0]
    v_pk_mul_f32 v[168:169], v[168:169], v[10:11] op_sel:[0,0] op_sel_hi:[1,0]
    v_pk_mul_f32 v[170:171], v[170:171], v[10:11] op_sel:[0,0] op_sel_hi:[1,0]
    v_pk_mul_f32 v[172:173], v[172:173], v[10:11] op_sel:[0,0] op_sel_hi:[1,0]
    v_pk_mul_f32 v[174:175], v[174:175], v[10:11] op_sel:[0,0] op_sel_hi:[1,0]
    v_cvt_pk_bf16_f32 v208, v208, v209
    v_cvt_pk_bf16_f32 v209, v210, v211
    v_cvt_pk_bf16_f32 v210, v212, v213
    v_cvt_pk_bf16_f32 v211, v214, v215
    v_cvt_pk_bf16_f32 v212, v216, v217
    v_cvt_pk_bf16_f32 v213, v218, v219
    v_cvt_pk_bf16_f32 v214, v220, v221
    v_cvt_pk_bf16_f32 v215, v222, v223
    v_cvt_pk_bf16_f32 v160, v160, v161
    v_cvt_pk_bf16_f32 v161, v162, v163
    v_cvt_pk_bf16_f32 v162, v164, v165
    v_cvt_pk_bf16_f32 v163, v166, v167
    v_cvt_pk_bf16_f32 v164, v168, v169
    v_cvt_pk_bf16_f32 v165, v170, v171
    v_cvt_pk_bf16_f32 v166, v172, v173
    v_cvt_pk_bf16_f32 v167, v174, v175
    s_waitcnt vmcnt(0)
    v_readlane_b32 s23, v0, 10
    s_nop 0
    s_cmp_ge_u32 s23, 16
    s_nop 2
    s_cbranch_scc1 apk_5
    s_mov_b32 s28, 0
    s_mov_b64 exec, 1024
    s_nop 0
apl_6:
    buffer_load_dword v0, off, s[4:7], s39 sc1
    s_add_u32 s28, s28, 1
    s_cmp_gt_u32 s28, 1000000
    s_cbranch_scc1 apl_6_x
    s_waitcnt vmcnt(0)
    v_readlane_b32 s23, v0, 10
    s_nop 0
    s_cmp_lt_u32 s23, 16
    s_nop 2
    s_cbranch_scc1 apl_6
apl_6_x:
    s_waitcnt vmcnt(0)
    s_mov_b64 exec, -1
    s_nop 0
apk_5:
    buffer_load_dwordx4 v[80:83], v1, s[4:7], s34 offen sc1
    buffer_load_dwordx4 v[84:87], v1, s[4:7], s34 offen offset:1024 sc1
    buffer_load_dwordx4 v[88:91], v1, s[4:7], s34 offen offset:2048 sc1
    buffer_load_dwordx4 v[92:95], v1, s[4:7], s34 offen offset:3072 sc1
    s_add_u32 s34, s34, 4096
    buffer_load_dwordx4 v[96:99], v1, s[4:7], s34 offen sc1
    buffer_load_dwordx4 v[100:103], v1, s[4:7], s34 offen offset:1024 sc1
    buffer_load_dwordx4 v[104:107], v1, s[4:7], s34 offen offset:2048 sc1
    buffer_load_dwordx4 v[108:111], v1, s[4:7], s34 offen offset:3072 sc1
    s_add_u32 s34, s34, 4096
    buffer_load_dwordx4 v[112:115], v1, s[4:7], s34 offen sc1
    buffer_load_dwordx4 v[116:119], v1, s[4:7], s34 offen offset:1024 sc1
    buffer_load_dwordx4 v[120:123], v1, s[4:7], s34 offen offset:2048 sc1
    buffer_load_dwordx4 v[124:127], v1, s[4:7], s34 offen offset:3072 sc1
    s_add_u32 s34, s34, 4096
    buffer_load_dwordx4 v[128:131], v1, s[4:7], s34 offen sc1
    buffer_load_dwordx4 v[132:135], v1, s[4:7], s34 offen offset:1024 sc1
    buffer_load_dwordx4 v[136:139], v1, s[4:7], s34 offen offset:2048 sc1
    buffer_load_dwordx4 v[140:143], v1, s[4:7], s34 offen offset:3072 sc1
    s_waitcnt vmcnt(15)
    v_dot2_f32_bf16 v176, v80, s24, 0
    v_dot2_f32_bf16 v177, v80, s25, 0
    v_dot2_f32_bf16 v178, v81, s24, 0
    v_dot2_f32_bf16 v179, v81, s25, 0
    v_dot2_f32_bf16 v180, v82, s24, 0
    v_dot2_f32_bf16 v181, v82, s25, 0
    v_dot2_f32_bf16 v182, v83, s24, 0
    v_dot2_f32_bf16 v183, v83, s25, 0
    s_waitcnt vmcnt(14)
    v_dot2_f32_bf16 v176, v84, s24, v176
    v_dot2_f32_bf16 v177, v84, s25, v177
    v_dot2_f32_bf16 v178, v85, s24, v178
    v_dot2_f32_bf16 v179, v85, s25, v179
    v_dot2_f32_bf16 v180, v86, s24, v180
    v_dot2_f32_bf16 v181, v86, s25, v181
    v_dot2_f32_bf16 v182, v87, s24, v182
    v_dot2_f32_bf16 v183, v87, s25, v183
    s_waitcnt vmcnt(13)
    v_dot2_f32_bf16 v176, v88, s24, v176
    v_dot2_f32_bf16 v177, v88, s25, v177
    v_dot2_f32_bf16 v178, v89, s24, v178
    v_dot2_f32_bf16 v179, v89, s25, v179
    v_dot2_f32_bf16 v180, v90, s24, v180
    v_dot2_f32_bf16 v181, v90, s25, v181
    v_dot2_f32_bf16 v182, v91, s24, v182
    v_dot2_f32_bf16 v183, v91, s25, v183
    s_waitcnt vmcnt(12)
    v_dot2_f32_bf16 v176, v92, s24, v176
    v_dot2_f32_bf16 v177, v92, s25, v177
    v_dot2_f32_bf16 v178, v93, s24, v178
    v_dot2_f32_bf16 v179, v93, s25, v179
    v_dot2_f32_bf16 v180, v94, s24, v180
    v_dot2_f32_bf16 v181, v94, s25, v181
    v_dot2_f32_bf16 v182, v95, s24, v182
    v_dot2_f32_bf16 v183, v95, s25, v183
    buffer_load_dwordx4 v[60:63], v1, s[4:7], s43 offen offset:3072
    s_add_u32 s43, s43, 4096
    s_waitcnt vmcnt(12)
    v_dot2_f32_bf16 v176, v96, s24, v176
    v_dot2_f32_bf16 v177, v96, s25, v177
    v_dot2_f32_bf16 v178, v97, s24, v178
    v_dot2_f32_bf16 v179, v97, s25, v179
    v_dot2_f32_bf16 v180, v98, s24, v180
    v_dot2_f32_bf16 v181, v98, s25, v181
    v_dot2_f32_bf16 v182, v99, s24, v182
    v_dot2_f32_bf16 v183, v99, s25, v183
    buffer_load_dwordx4 v[32:35], v1, s[4:7], s42 offen
    s_waitcnt vmcnt(12)
    v_dot2_f32_bf16 v176, v100, s24, v176
    v_dot2_f32_bf16 v177, v100, s25, v177
    v_dot2_f32_bf16 v178, v101, s24, v178
    v_dot2_f32_bf16 v179, v101, s25, v179
    v_dot2_f32_bf16 v180, v102, s24, v180
    v_dot2_f32_bf16 v181, v102, s25, v181
    v_dot2_f32_bf16 v182, v103, s24, v182
    v_dot2_f32_bf16 v183, v103, s25, v183
    buffer_load_dwordx4 v[64:67], v1, s[4:7], s43 offen
    s_waitcnt vmcnt(12)
    v_dot2_f32_bf16 v176, v104, s24, v176
    v_dot2_f32_bf16 v177, v104, s25, v177
    v_dot2_f32_bf16 v178, v105, s24, v178
    v_dot2_f32_bf16 v179, v105, s25, v179
    v_dot2_f32_bf16 v180, v106, s24, v180
    v_dot2_f32_bf16 v181, v106, s25, v181
    v_dot2_f32_bf16 v182, v107, s24, v182
    v_dot2_f32_bf16 v183, v107, s25, v183
    buffer_load_dwordx4 v[36:39], v1, s[4:7], s42 offen offset:1024
    s_waitcnt vmcnt(12)
    v_dot2_f32_bf16 v176, v108, s24, v176
    v_dot2_f32_bf16 v177, v108, s25, v177
    v_dot2_f32_bf16 v178, v109, s24, v178
    v_dot2_f32_bf16 v179, v109, s25, v179
    v_dot2_f32_bf16 v180, v110, s24, v180
    v_dot2_f32_bf16 v181, v110, s25, v181
    v_dot2_f32_bf16 v182, v111, s24, v182
    v_dot2_f32_bf16 v183, v111, s25, v183
    s_waitcnt vmcnt(11)
    v_dot2_f32_bf16 v176, v112, s24, v176
    v_dot2_f32_bf16 v177, v112, s25, v177
    v_dot2_f32_bf16 v178, v113, s24, v178
    v_dot2_f32_bf16 v179, v113, s25, v179
    v_dot2_f32_bf16 v180, v114, s24, v180
    v_dot2_f32_bf16 v181, v114, s25, v181
    v_dot2_f32_bf16 v182, v115, s24, v182
    v_dot2_f32_bf16 v183, v115, s25, v183
    s_waitcnt vmcnt(10)
    v_dot2_f32_bf16 v176, v116, s24, v176
    v_dot2_f32_bf16 v177, v116, s25, v177
    v_dot2_f32_bf16 v178, v117, s24, v178
    v_dot2_f32_bf16 v179, v117, s25, v179
    v_dot2_f32_bf16 v180, v118, s24, v180
    v_dot2_f32_bf16 v181, v118, s25, v181
    v_dot2_f32_bf16 v182, v119, s24, v182
    v_dot2_f32_bf16 v183, v119, s25, v183
    s_waitcnt vmcnt(9)
    v_dot2_f32_bf16 v176, v120, s24, v176
    v_dot2_f32_bf16 v177, v120, s25, v177
    v_dot2_f32_bf16 v178, v121, s24, v178
    v_dot2_f32_bf16 v179, v121, s25, v179
    v_dot2_f32_bf16 v180, v122, s24, v180
    v_dot2_f32_bf16 v181, v122, s25, v181
    v_dot2_f32_bf16 v182, v123, s24, v182
    v_dot2_f32_bf16 v183, v123, s25, v183
    s_waitcnt vmcnt(8)
    v_dot2_f32_bf16 v176, v124, s24, v176
    v_dot2_f32_bf16 v177, v124, s25, v177
    v_dot2_f32_bf16 v178, v125, s24, v178
    v_dot2_f32_bf16 v179, v125, s25, v179
    v_dot2_f32_bf16 v180, v126, s24, v180
    v_dot2_f32_bf16 v181, v126, s25, v181
    v_dot2_f32_bf16 v182, v127, s24, v182
    v_dot2_f32_bf16 v183, v127, s25, v183
    s_waitcnt vmcnt(7)
    v_dot2_f32_bf16 v176, v128, s24, v176
    v_dot2_f32_bf16 v177, v128, s25, v177
    v_dot2_f32_bf16 v178, v129, s24, v178
    v_dot2_f32_bf16 v179, v129, s25, v179
    v_dot2_f32_bf16 v180, v130, s24, v180
    v_dot2_f32_bf16 v181, v130, s25, v181
    v_dot2_f32_bf16 v182, v131, s24, v182
    v_dot2_f32_bf16 v183, v131, s25, v183
    s_waitcnt vmcnt(6)
    v_dot2_f32_bf16 v176, v132, s24, v176
    v_dot2_f32_bf16 v177, v132, s25, v177
    v_dot2_f32_bf16 v178, v133, s24, v178
    v_dot2_f32_bf16 v179, v133, s25, v179
    v_dot2_f32_bf16 v180, v134, s24, v180
    v_dot2_f32_bf16 v181, v134, s25, v181
    v_dot2_f32_bf16 v182, v135, s24, v182
    v_dot2_f32_bf16 v183, v135, s25, v183
    s_waitcnt vmcnt(5)
    v_dot2_f32_bf16 v176, v136, s24, v176
    v_dot2_f32_bf16 v177, v136, s25, v177
    v_dot2_f32_bf16 v178, v137, s24, v178
    v_dot2_f32_bf16 v179, v137, s25, v179
    v_dot2_f32_bf16 v180, v138, s24, v180
    v_dot2_f32_bf16 v181, v138, s25, v181
    v_dot2_f32_bf16 v182, v139, s24, v182
    v_dot2_f32_bf16 v183, v139, s25, v183
    s_waitcnt vmcnt(4)
    v_dot2_f32_bf16 v176, v140, s24, v176
    v_dot2_f32_bf16 v177, v140, s25, v177
    v_dot2_f32_bf16 v178, v141, s24, v178
    v_dot2_f32_bf16 v179, v141, s25, v179
    v_dot2_f32_bf16 v180, v142, s24, v180
    v_dot2_f32_bf16 v181, v142, s25, v181
    v_dot2_f32_bf16 v182, v143, s24, v182
    v_dot2_f32_bf16 v183, v143, s25, v183
    s_lshl_b32 s20, s14, 10
    s_add_u32 s20, s20, 121856
    v_add_u32 v8, s20, v1
    s_lshl_b32 s32, s52, 15
    s_lshl_b32 s23, s13, 11
    s_add_u32 s32, s32, s23
    s_lshl_b32 s23, s15, 21
    s_add_u32 s32, s32, s23
    s_add_u32 s32, s32, 17203200
    v_cvt_pk_bf16_f32 v184, v176, v177
    v_cvt_pk_bf16_f32 v185, v178, v179
    v_cvt_pk_bf16_f32 v186, v180, v181
    v_cvt_pk_bf16_f32 v187, v182, v183
    ds_write_b128 v8, v[184:187]
    s_waitcnt lgkmcnt(0)
    s_barrier
    ds_read_b128 v[188:191], v2 offset:56320
    ds_read_b128 v[192:195], v2 offset:57344
    ds_read_b128 v[196:199], v2 offset:58368
    ds_read_b128 v[200:203], v2 offset:59392
    s_waitcnt lgkmcnt(3)
    v_mfma_f32_32x32x16_bf16 v[224:239], v[188:191], v[208:211], 0
    s_waitcnt lgkmcnt(2)
    v_mfma_f32_32x32x16_bf16 v[224:239], v[192:195], v[212:215], v[224:239]
    s_waitcnt lgkmcnt(1)
    v_mfma_f32_32x32x16_bf16 v[224:239], v[196:199], v[160:163], v[224:239]
    s_waitcnt lgkmcnt(0)
    v_mfma_f32_32x32x16_bf16 v[224:239], v[200:203], v[164:167], v[224:239]
    s_nop 11
    v_mov_b32 v8, v236
    v_mov_b32 v9, v236
    s_nop 1
    v_permlane32_swap_b32 v8, v9
    v_add_f32 v9, 0x358637bd, v9
    v_rcp_f32 v9, v9
    s_nop 0
    v_pk_mul_f32 v[224:225], v[224:225], v[8:9] op_sel:[0,1] op_sel_hi:[1,1]
    v_pk_mul_f32 v[226:227], v[226:227], v[8:9] op_sel:[0,1] op_sel_hi:[1,1]
    v_pk_mul_f32 v[228:229], v[228:229], v[8:9] op_sel:[0,1] op_sel_hi:[1,1]
    v_pk_mul_f32 v[230:231], v[230:231], v[8:9] op_sel:[0,1] op_sel_hi:[1,1]
    v_pk_mul_f32 v[232:233], v[232:233], v[8:9] op_sel:[0,1] op_sel_hi:[1,1]
    v_pk_mul_f32 v[234:235], v[234:235], v[8:9] op_sel:[0,1] op_sel_hi:[1,1]
    v_pk_mul_f32 v[236:237], v[236:237], v[8:9] op_sel:[0,1] op_sel_hi:[1,1]
    v_pk_mul_f32 v[238:239], v[238:239], v[8:9] op_sel:[0,1] op_sel_hi:[1,1]
    v_cvt_pk_bf16_f32 v240, v224, v225
    v_cvt_pk_bf16_f32 v241, v226, v227
    v_cvt_pk_bf16_f32 v242, v228, v229
    v_cvt_pk_bf16_f32 v243, v230, v231
    v_cvt_pk_bf16_f32 v244, v232, v233
    v_cvt_pk_bf16_f32 v245, v234, v235
    v_cvt_pk_bf16_f32 v246, v236, v237
    v_cvt_pk_bf16_f32 v247, v238, v239
    buffer_store_dwordx4 v[240:243], v1, s[4:7], s32 offen sc1
    buffer_store_dwordx4 v[244:247], v1, s[4:7], s32 offen offset:1024 sc1
    s_waitcnt vmcnt(0)
    s_barrier
    s_add_u32 s22, s48, 2048
    v_mov_b32 v15, 1
    s_cmp_eq_u32 s14, 0
    s_cselect_b64 exec, 1, 0
    buffer_atomic_add v15, off, s[4:7], s22 sc1
    s_mov_b64 exec, -1
    buffer_load_dwordx4 v[68:71], v1, s[4:7], s43 offen offset:1024
    buffer_load_dwordx4 v[40:43], v1, s[4:7], s42 offen offset:2048
    buffer_load_dwordx4 v[72:75], v1, s[4:7], s43 offen offset:2048
    buffer_load_dwordx4 v[44:47], v1, s[4:7], s42 offen offset:3072
    buffer_load_dwordx4 v[76:79], v1, s[4:7], s43 offen offset:3072
    buffer_load_dwordx4 a[128:131], v1, s[4:7], s40 offen
    buffer_load_dwordx4 a[132:135], v1, s[4:7], s41 offen
    buffer_load_dwordx4 a[136:139], v1, s[4:7], s40 offen offset:1024
    buffer_load_dwordx4 a[140:143], v1, s[4:7], s41 offen offset:1024
    s_cmp_lt_u32 s30, 7
    s_cbranch_scc1 main_kernel_act
    s_cmp_lg_u32 s15, 0
    s_cbranch_scc1 main_kernel_done
    s_waitcnt vmcnt(0)
    s_branch main_kernel_next
main_kernel_act:
    s_xor_b32 s32, s50, 0
    s_lshl_b32 s32, s32, 15
    s_lshl_b32 s20, s14, 13
    s_lshl_b32 s23, s15, 21
    s_add_u32 s20, s20, s23
    s_add_u32 s20, s20, 17203200
    s_add_u32 s32, s32, s20
    s_xor_b32 s33, s50, 1
    s_lshl_b32 s33, s33, 15
    s_lshl_b32 s20, s14, 13
    s_lshl_b32 s23, s15, 21
    s_add_u32 s20, s20, s23
    s_add_u32 s20, s20, 17203200
    s_add_u32 s33, s33, s20
    s_add_u32 s22, s48, 2048
    s_cmp_lg_u32 s14, 0
    s_cbranch_scc1 pol_7
    s_mov_b32 s28, 0
    s_mov_b64 exec, 1
    buffer_load_dword v0, off, s[4:7], s22 sc1
plp_8:
    s_waitcnt vmcnt(0)
    v_readlane_b32 s23, v0, 0
    s_nop 0
    s_cmp_ge_u32 s23, 16
    s_nop 2
    s_cbranch_scc1 plx_9
    s_mov_b64 exec, 1
    buffer_load_dword v0, off, s[4:7], s22 sc1
    s_add_u32 s28, s28, 1
    s_cmp_lt_u32 s28, 1000000
    s_cbranch_scc1 plp_8
plx_9:
    s_mov_b64 exec, -1
    s_nop 0
pol_7:
    s_barrier
    buffer_load_dwordx4 v[112:115], v1, s[4:7], s33 offen sc1
    buffer_load_dwordx4 v[116:119], v1, s[4:7], s33 offen offset:1024 sc1
    buffer_load_dwordx4 v[120:123], v1, s[4:7], s33 offen offset:2048 sc1
    buffer_load_dwordx4 v[124:127], v1, s[4:7], s33 offen offset:3072 sc1
    s_add_u32 s33, s33, 4096
    buffer_load_dwordx4 v[128:131], v1, s[4:7], s33 offen sc1
    buffer_load_dwordx4 v[132:135], v1, s[4:7], s33 offen offset:1024 sc1
    buffer_load_dwordx4 v[136:139], v1, s[4:7], s33 offen offset:2048 sc1
    buffer_load_dwordx4 v[140:143], v1, s[4:7], s33 offen offset:3072 sc1
    buffer_load_dwordx4 v[80:83], v1, s[4:7], s32 offen sc1
    buffer_load_dwordx4 v[84:87], v1, s[4:7], s32 offen offset:1024 sc1
    buffer_load_dwordx4 v[88:91], v1, s[4:7], s32 offen offset:2048 sc1
    buffer_load_dwordx4 v[92:95], v1, s[4:7], s32 offen offset:3072 sc1
    s_add_u32 s32, s32, 4096
    buffer_load_dwordx4 v[96:99], v1, s[4:7], s32 offen sc1
    buffer_load_dwordx4 v[100:103], v1, s[4:7], s32 offen offset:1024 sc1
    buffer_load_dwordx4 v[104:107], v1, s[4:7], s32 offen offset:2048 sc1
    buffer_load_dwordx4 v[108:111], v1, s[4:7], s32 offen offset:3072 sc1
    s_xor_b32 s20, s14, 1
    s_mul_i32 s20, s20, 12288
    s_add_u32 s20, s20, 89088
    v_add_u32 v9, s20, v1
    s_xor_b32 s20, s14, 2
    s_mul_i32 s20, s20, 12288
    s_add_u32 s20, s20, 93184
    v_add_u32 v10, s20, v1
    s_xor_b32 s20, s14, 3
    s_mul_i32 s20, s20, 12288
    s_add_u32 s20, s20, 97280
    v_add_u32 v11, s20, v1
    s_mul_i32 s20, s14, 12288
    s_add_u32 s20, s20, 89088
    v_add_u32 v8, s20, v1
    s_mul_i32 s38, s50, 28672
    s_lshl_b32 s23, s51, 11
    s_add_u32 s38, s38, s23
    s_mul_i32 s23, s15, 3670016
    s_add_u32 s38, s38, s23
    s_add_u32 s38, s38, 8683520
    s_mul_i32 s39, s50, 3584
    s_lshl_b32 s23, s51, 8
    s_add_u32 s39, s39, s23
    s_mul_i32 s23, s15, 458752
    s_add_u32 s39, s39, s23
    s_add_u32 s39, s39, 14417920
    s_waitcnt vmcnt(15)
    v_mfma_f32_32x32x16_bf16 v[176:191], v[16:19], v[112:115], 0
    v_mfma_f32_32x32x16_bf16 v[192:207], v[48:51], v[112:115], 0
    buffer_load_dwordx4 a[144:147], v1, s[4:7], s40 offen offset:2048
    s_waitcnt vmcnt(15)
    v_mfma_f32_32x32x16_bf16 v[176:191], v[20:23], v[116:119], v[176:191]
    v_mfma_f32_32x32x16_bf16 v[192:207], v[52:55], v[116:119], v[192:207]
    buffer_load_dwordx4 a[148:151], v1, s[4:7], s41 offen offset:2048
    s_waitcnt vmcnt(15)
    v_mfma_f32_32x32x16_bf16 v[176:191], v[24:27], v[120:123], v[176:191]
    v_mfma_f32_32x32x16_bf16 v[192:207], v[56:59], v[120:123], v[192:207]
    buffer_load_dwordx4 a[152:155], v1, s[4:7], s40 offen offset:3072
    s_add_u32 s40, s40, 4096
    s_waitcnt vmcnt(15)
    v_mfma_f32_32x32x16_bf16 v[176:191], v[28:31], v[124:127], v[176:191]
    v_mfma_f32_32x32x16_bf16 v[192:207], v[60:63], v[124:127], v[192:207]
    buffer_load_dwordx4 a[156:159], v1, s[4:7], s41 offen offset:3072
    s_add_u32 s41, s41, 4096
    s_waitcnt vmcnt(15)
    v_mfma_f32_32x32x16_bf16 v[176:191], v[32:35], v[128:131], v[176:191]
    v_mfma_f32_32x32x16_bf16 v[192:207], v[64:67], v[128:131], v[192:207]
    buffer_load_dwordx4 a[160:163], v1, s[4:7], s40 offen
    s_waitcnt vmcnt(15)
    v_mfma_f32_32x32x16_bf16 v[176:191], v[36:39], v[132:135], v[176:191]
    v_mfma_f32_32x32x16_bf16 v[192:207], v[68:71], v[132:135], v[192:207]
    buffer_load_dwordx4 a[164:167], v1, s[4:7], s41 offen
    s_waitcnt vmcnt(15)
    v_mfma_f32_32x32x16_bf16 v[176:191], v[40:43], v[136:139], v[176:191]
    v_mfma_f32_32x32x16_bf16 v[192:207], v[72:75], v[136:139], v[192:207]
    buffer_load_dwordx4 a[168:171], v1, s[4:7], s40 offen offset:1024
    s_waitcnt vmcnt(15)
    v_mfma_f32_32x32x16_bf16 v[176:191], v[44:47], v[140:143], v[176:191]
    v_mfma_f32_32x32x16_bf16 v[192:207], v[76:79], v[140:143], v[192:207]
    buffer_load_dwordx4 a[172:175], v1, s[4:7], s41 offen offset:1024
    s_waitcnt vmcnt(15)
    v_mfma_f32_32x32x16_bf16 v[160:175], v[48:51], v[80:83], 0
    v_accvgpr_read_b32 v224, a248
    v_accvgpr_read_b32 v225, a249
    v_accvgpr_read_b32 v226, a250
    v_mfma_f32_32x32x16_bf16 v[144:159], v[16:19], v[80:83], 0
    buffer_load_dwordx4 a[176:179], v1, s[4:7], s40 offen offset:2048
    s_waitcnt vmcnt(15)
    v_mfma_f32_32x32x16_bf16 v[160:175], v[52:55], v[84:87], v[160:175]
    v_accvgpr_read_b32 v227, a251
    v_accvgpr_read_b32 v228, a252
    v_accvgpr_read_b32 v229, a253
    v_mfma_f32_32x32x16_bf16 v[144:159], v[20:23], v[84:87], v[144:159]
    buffer_load_dwordx4 a[180:183], v1, s[4:7], s41 offen offset:2048
    s_waitcnt vmcnt(15)
    v_mfma_f32_32x32x16_bf16 v[160:175], v[56:59], v[88:91], v[160:175]
    ds_write_b128 v10, v[176:179] offset:0
    v_accvgpr_read_b32 v230, a254
    v_accvgpr_read_b32 v231, a255
    v_lshlrev_b32 v208, 16, v224
    v_mfma_f32_32x32x16_bf16 v[144:159], v[24:27], v[88:91], v[144:159]
    ds_write_b128 v10, v[180:183] offset:1024
    buffer_load_dwordx4 a[184:187], v1, s[4:7], s40 offen offset:3072
    s_add_u32 s40, s40, 4096
    s_waitcnt vmcnt(15)
    v_mfma_f32_32x32x16_bf16 v[160:175], v[60:63], v[92:95], v[160:175]
    ds_write_b128 v10, v[184:187] offset:2048
    v_and_b32 v209, 0xffff0000, v224
    v_lshlrev_b32 v210, 16, v225
    v_and_b32 v211, 0xffff0000, v225
    v_mfma_f32_32x32x16_bf16 v[144:159], v[28:31], v[92:95], v[144:159]
    ds_write_b128 v10, v[188:191] offset:3072
    buffer_load_dwordx4 a[188:191], v1, s[4:7], s41 offen offset:3072
    s_add_u32 s41, s41, 4096
    s_waitcnt vmcnt(15)
    v_mfma_f32_32x32x16_bf16 v[160:175], v[64:67], v[96:99], v[160:175]
    ds_write_b128 v11, v[192:195] offset:0
    v_lshlrev_b32 v212, 16, v226
    v_and_b32 v213, 0xffff0000, v226
    v_lshlrev_b32 v214, 16, v227
    v_mfma_f32_32x32x16_bf16 v[144:159], v[32:35], v[96:99], v[144:159]
    ds_write_b128 v11, v[196:199] offset:1024
    buffer_load_dwordx4 a[192:195], v1, s[4:7], s40 offen
    s_waitcnt vmcnt(15)
    v_mfma_f32_32x32x16_bf16 v[160:175], v[68:71], v[100:103], v[160:175]
    ds_write_b128 v11, v[200:203] offset:2048
    v_and_b32 v215, 0xffff0000, v227
    v_lshlrev_b32 v216, 16, v228
    v_and_b32 v217, 0xffff0000, v228
    v_mfma_f32_32x32x16_bf16 v[144:159], v[36:39], v[100:103], v[144:159]
    ds_write_b128 v11, v[204:207] offset:3072
    buffer_load_dwordx4 a[196:199], v1, s[4:7], s41 offen
    s_waitcnt vmcnt(15)
    v_mfma_f32_32x32x16_bf16 v[160:175], v[72:75], v[104:107], v[160:175]
    v_lshlrev_b32 v218, 16, v229
    v_and_b32 v219, 0xffff0000, v229
    v_lshlrev_b32 v220, 16, v230
    v_mfma_f32_32x32x16_bf16 v[144:159], v[40:43], v[104:107], v[144:159]
    buffer_load_dwordx4 a[200:203], v1, s[4:7], s40 offen offset:1024
    s_waitcnt vmcnt(15)
    v_mfma_f32_32x32x16_bf16 v[160:175], v[76:79], v[108:111], v[160:175]
    v_and_b32 v221, 0xffff0000, v230
    v_lshlrev_b32 v222, 16, v231
    v_and_b32 v223, 0xffff0000, v231
    v_mfma_f32_32x32x16_bf16 v[144:159], v[44:47], v[108:111], v[144:159]
    buffer_load_dwordx4 a[204:207], v1, s[4:7], s41 offen offset:1024
    s_nop 6
    ds_write_b128 v9, v[160:163] offset:0
    ds_write_b128 v9, v[164:167] offset:1024
    ds_write_b128 v9, v[168:171] offset:2048
    ds_write_b128 v9, v[172:175] offset:3072
    v_pk_add_f32 v[144:145], v[144:145], v[208:209]
    v_pk_add_f32 v[146:147], v[146:147], v[210:211]
    v_pk_add_f32 v[148:149], v[148:149], v[212:213]
    v_pk_add_f32 v[150:151], v[150:151], v[214:215]
    v_pk_add_f32 v[152:153], v[152:153], v[216:217]
    v_pk_add_f32 v[154:155], v[154:155], v[218:219]
    v_pk_add_f32 v[156:157], v[156:157], v[220:221]
    v_pk_add_f32 v[158:159], v[158:159], v[222:223]
    s_waitcnt lgkmcnt(0)
    s_barrier
    ds_read_b128 v[160:163], v8 offset:0
    ds_read_b128 v[164:167], v8 offset:1024
    ds_read_b128 v[168:171], v8 offset:2048
    ds_read_b128 v[172:175], v8 offset:3072
    ds_read_b128 v[176:179], v8 offset:4096
    ds_read_b128 v[180:183], v8 offset:5120
    ds_read_b128 v[184:187], v8 offset:6144
    ds_read_b128 v[188:191], v8 offset:7168
    ds_read_b128 v[192:195], v8 offset:8192
    ds_read_b128 v[196:199], v8 offset:9216
    ds_read_b128 v[200:203], v8 offset:10240
    ds_read_b128 v[204:207], v8 offset:11264
    s_waitcnt lgkmcnt(8)
    v_pk_add_f32 v[144:145], v[144:145], v[160:161]
    v_pk_add_f32 v[146:147], v[146:147], v[162:163]
    v_pk_add_f32 v[148:149], v[148:149], v[164:165]
    v_pk_add_f32 v[150:151], v[150:151], v[166:167]
    v_pk_add_f32 v[152:153], v[152:153], v[168:169]
    v_pk_add_f32 v[154:155], v[154:155], v[170:171]
    v_pk_add_f32 v[156:157], v[156:157], v[172:173]
    v_pk_add_f32 v[158:159], v[158:159], v[174:175]
    s_waitcnt lgkmcnt(4)
    v_pk_add_f32 v[144:145], v[144:145], v[176:177]
    v_pk_add_f32 v[146:147], v[146:147], v[178:179]
    v_pk_add_f32 v[148:149], v[148:149], v[180:181]
    v_pk_add_f32 v[150:151], v[150:151], v[182:183]
    v_pk_add_f32 v[152:153], v[152:153], v[184:185]
    v_pk_add_f32 v[154:155], v[154:155], v[186:187]
    v_pk_add_f32 v[156:157], v[156:157], v[188:189]
    v_pk_add_f32 v[158:159], v[158:159], v[190:191]
    s_waitcnt lgkmcnt(0)
    v_pk_add_f32 v[144:145], v[144:145], v[192:193]
    v_pk_add_f32 v[146:147], v[146:147], v[194:195]
    v_pk_add_f32 v[148:149], v[148:149], v[196:197]
    v_pk_add_f32 v[150:151], v[150:151], v[198:199]
    v_pk_add_f32 v[152:153], v[152:153], v[200:201]
    v_pk_add_f32 v[154:155], v[154:155], v[202:203]
    v_pk_add_f32 v[156:157], v[156:157], v[204:205]
    v_pk_add_f32 v[158:159], v[158:159], v[206:207]
    v_cvt_pk_bf16_f32 v208, v144, v145
    v_cvt_pk_bf16_f32 v209, v146, v147
    v_cvt_pk_bf16_f32 v210, v148, v149
    v_cvt_pk_bf16_f32 v211, v150, v151
    v_cvt_pk_bf16_f32 v212, v152, v153
    v_cvt_pk_bf16_f32 v213, v154, v155
    v_cvt_pk_bf16_f32 v214, v156, v157
    v_cvt_pk_bf16_f32 v215, v158, v159
    buffer_store_dwordx4 v[208:211], v1, s[4:7], s38 offen sc1
    buffer_store_dwordx4 v[212:215], v1, s[4:7], s38 offen offset:1024 sc1
    v_pk_add_f32 v[216:217], v[144:145], v[146:147]
    v_pk_mul_f32 v[218:219], v[144:145], v[144:145]
    v_pk_fma_f32 v[218:219], v[146:147], v[146:147], v[218:219]
    v_pk_add_f32 v[216:217], v[216:217], v[148:149]
    v_pk_fma_f32 v[218:219], v[148:149], v[148:149], v[218:219]
    v_pk_add_f32 v[216:217], v[216:217], v[150:151]
    v_pk_fma_f32 v[218:219], v[150:151], v[150:151], v[218:219]
    v_pk_add_f32 v[216:217], v[216:217], v[152:153]
    v_pk_fma_f32 v[218:219], v[152:153], v[152:153], v[218:219]
    v_pk_add_f32 v[216:217], v[216:217], v[154:155]
    v_pk_fma_f32 v[218:219], v[154:155], v[154:155], v[218:219]
    v_pk_add_f32 v[216:217], v[216:217], v[156:157]
    v_pk_fma_f32 v[218:219], v[156:157], v[156:157], v[218:219]
    v_pk_add_f32 v[216:217], v[216:217], v[158:159]
    v_pk_fma_f32 v[218:219], v[158:159], v[158:159], v[218:219]
    v_add_f32 v216, v216, v217
    v_add_f32 v217, v218, v219
    v_mov_b32 v218, v216
    v_mov_b32 v219, v217
    s_nop 0
    v_permlane32_swap_b32 v218, v216
    v_permlane32_swap_b32 v219, v217
    v_pk_add_f32 v[216:217], v[216:217], v[218:219]
    s_mov_b32 exec_hi, 0
    buffer_store_dwordx2 v[216:217], v4, s[4:7], s39 offen sc1
    s_mov_b32 exec_hi, -1
    v_accvgpr_write_b32 a248, v208
    v_accvgpr_write_b32 a249, v209
    v_accvgpr_write_b32 a250, v210
    v_accvgpr_write_b32 a251, v211
    v_accvgpr_write_b32 a252, v212
    v_accvgpr_write_b32 a253, v213
    v_accvgpr_write_b32 a254, v214
    v_accvgpr_write_b32 a255, v215
    s_waitcnt vmcnt(0)
    s_barrier
    s_add_u32 s22, s48, 4096
    v_mov_b32 v15, 1
    s_cmp_eq_u32 s14, 0
    s_cselect_b64 exec, 1, 0
    buffer_atomic_add v15, off, s[4:7], s22 sc1
    s_mov_b64 exec, -1
    buffer_load_dwordx4 a[208:211], v1, s[4:7], s40 offen offset:2048
    buffer_load_dwordx4 a[212:215], v1, s[4:7], s41 offen offset:2048
    buffer_load_dwordx4 a[216:219], v1, s[4:7], s40 offen offset:3072
    s_add_u32 s40, s40, 4096
    buffer_load_dwordx4 a[220:223], v1, s[4:7], s41 offen offset:3072
    s_add_u32 s41, s41, 4096
    buffer_load_dwordx4 a[224:227], v1, s[4:7], s40 offen
    buffer_load_dwordx4 a[228:231], v1, s[4:7], s41 offen
    s_xor_b32 s20, s31, 0
    s_mul_i32 s56, s20, 28672
    s_mul_i32 s23, s12, 114688
    s_add_u32 s56, s56, s23
    s_mul_i32 s23, s14, 7168
    s_add_u32 s56, s56, s23
    s_mul_i32 s23, s15, 3670016
    s_add_u32 s56, s56, s23
    s_add_u32 s56, s56, 8683520
    s_mul_i32 s57, s14, 7168
    s_add_u32 s57, s57, 89088
    s_xor_b32 s20, s31, 1
    s_mul_i32 s58, s20, 28672
    s_mul_i32 s23, s12, 114688
    s_add_u32 s58, s58, s23
    s_mul_i32 s23, s14, 7168
    s_add_u32 s58, s58, s23
    s_mul_i32 s23, s15, 3670016
    s_add_u32 s58, s58, s23
    s_add_u32 s58, s58, 8683520
    s_mul_i32 s59, s14, 7168
    s_add_u32 s59, s59, 117760
    s_xor_b32 s20, s31, 2
    s_mul_i32 s60, s20, 28672
    s_mul_i32 s23, s12, 114688
    s_add_u32 s60, s60, s23
    s_mul_i32 s23, s14, 7168
    s_add_u32 s60, s60, s23
    s_mul_i32 s23, s15, 3670016
    s_add_u32 s60, s60, s23
    s_add_u32 s60, s60, 8683520
    s_mul_i32 s61, s14, 7168
    s_add_u32 s61, s61, 89088
    s_xor_b32 s20, s31, 3
    s_mul_i32 s62, s20, 28672
    s_mul_i32 s23, s12, 114688
    s_add_u32 s62, s62, s23
    s_mul_i32 s23, s14, 7168
    s_add_u32 s62, s62, s23
    s_mul_i32 s23, s15, 3670016
    s_add_u32 s62, s62, s23
    s_add_u32 s62, s62, 8683520
    s_mul_i32 s63, s14, 7168
    s_add_u32 s63, s63, 117760
    s_mul_i32 s32, s52, 3584
    s_mul_i32 s23, s15, 458752
    s_add_u32 s32, s32, s23
    s_add_u32 s32, s32, 14417920
    v_add_u32 v13, 117760, v1
    s_mul_i32 s20, s14, 14
    s_add_u32 s20, s20, 56
    s_mul_i32 s23, s16, 56
    s_sub_u32 s20, s20, s23
    s_xor_b32 s88, s19, 0
    s_mul_i32 s88, s88, 112
    s_add_u32 s88, s88, s20
    s_mul_i32 s20, s17, 224
    s_add_u32 s88, s88, s20
    s_lshl_b32 s88, s88, 10
    s_add_u32 s88, s88, 5242880
    s_mul_i32 s20, s14, 14
    s_add_u32 s20, s20, 56
    s_mul_i32 s23, s16, 56
    s_sub_u32 s20, s20, s23
    s_xor_b32 s89, s19, 1
    s_mul_i32 s89, s89, 112
    s_add_u32 s89, s89, s20
    s_mul_i32 s20, s17, 224
    s_add_u32 s89, s89, s20
    s_lshl_b32 s89, s89, 10
    s_add_u32 s89, s89, 5242880
    s_mul_i32 s20, s16, 56
    s_mul_i32 s23, s14, 14
    s_add_u32 s20, s20, s23
    s_xor_b32 s90, s19, 0
    s_mul_i32 s90, s90, 112
    s_add_u32 s90, s90, s20
    s_mul_i32 s20, s17, 224
    s_add_u32 s90, s90, s20
    s_lshl_b32 s90, s90, 10
    s_add_u32 s90, s90, 5242880
    s_mul_i32 s20, s16, 56
    s_mul_i32 s23, s14, 14
    s_add_u32 s20, s20, s23
    s_xor_b32 s91, s19, 1
    s_mul_i32 s91, s91, 112
    s_add_u32 s91, s91, s20
    s_mul_i32 s20, s17, 224
    s_add_u32 s91, s91, s20
    s_lshl_b32 s91, s91, 10
    s_add_u32 s91, s91, 5242880
    s_add_u32 s22, s48, 4096
    s_cmp_lg_u32 s14, 0
    s_cbranch_scc1 pol_10
    s_mov_b32 s28, 0
    s_mov_b64 exec, 1
    buffer_load_dword v0, off, s[4:7], s22 sc1
plp_11:
    s_waitcnt vmcnt(0)
    v_readlane_b32 s23, v0, 0
    s_nop 0
    s_cmp_ge_u32 s23, 14
    s_nop 2
    s_cbranch_scc1 plx_12
    s_mov_b64 exec, 1
    buffer_load_dword v0, off, s[4:7], s22 sc1
    s_add_u32 s28, s28, 1
    s_cmp_lt_u32 s28, 1000000
    s_cbranch_scc1 plp_11
plx_12:
    s_mov_b64 exec, -1
    s_nop 0
pol_10:
    s_barrier
    s_mov_b32 m0, s57
    s_nop 0
    buffer_load_dwordx4 v1, s[4:7], s56 offen sc1 lds
    buffer_load_dwordx4 v1, s[4:7], s56 offen offset:1024 sc1 lds
    buffer_load_dwordx4 v1, s[4:7], s56 offen offset:2048 sc1 lds
    buffer_load_dwordx4 v1, s[4:7], s56 offen offset:3072 sc1 lds
    s_add_u32 s56, s56, 4096
    s_add_u32 s57, s57, 4096
    s_mov_b32 m0, s57
    s_nop 0
    buffer_load_dwordx4 v1, s[4:7], s56 offen sc1 lds
    buffer_load_dwordx4 v1, s[4:7], s56 offen offset:1024 sc1 lds
    buffer_load_dwordx4 v1, s[4:7], s56 offen offset:2048 sc1 lds
    buffer_load_dwordx2 v[100:101], v3, s[4:7], s32 offen sc1
    buffer_load_dwordx2 v[102:103], v3, s[4:7], s32 offen offset:256 sc1
    buffer_load_dwordx2 v[104:105], v3, s[4:7], s32 offen offset:512 sc1
    buffer_load_dwordx2 v[106:107], v3, s[4:7], s32 offen offset:768 sc1
    buffer_load_dwordx2 v[108:109], v3, s[4:7], s32 offen offset:1024 sc1
    buffer_load_dwordx2 v[110:111], v3, s[4:7], s32 offen offset:1280 sc1
    buffer_load_dwordx2 v[112:113], v3, s[4:7], s32 offen offset:1536 sc1
    s_waitcnt vmcnt(7)
    s_barrier
    ds_read_b128 v[80:83], v2 offset:23552
    ds_read_b128 v[84:87], v2 offset:24576
    ds_read_b128 v[88:91], v2 offset:25600
    ds_read_b128 v[92:95], v2 offset:26624
    s_waitcnt lgkmcnt(3)
    v_mfma_f32_32x32x16_bf16 v[16:31], a[0:3], v[80:83], 0
    s_waitcnt vmcnt(0)
    v_add_f32 v100, v100, v102
    v_add_f32 v104, v104, v106
    v_add_f32 v108, v108, v110
    v_add_f32 v101, v101, v103
    v_mfma_f32_32x32x16_bf16 v[32:47], a[4:7], v[80:83], 0
    s_mov_b32 m0, s59
    s_nop 0
    buffer_load_dwordx4 v1, s[4:7], s58 offen sc1 lds
    ds_read_b128 v[80:83], v2 offset:27648
    s_waitcnt lgkmcnt(3)
    v_mfma_f32_32x32x16_bf16 v[16:31], a[8:11], v[84:87], v[16:31]
    v_add_f32 v105, v105, v107
    v_add_f32 v109, v109, v111
    v_add_f32 v100, v100, v104
    v_add_f32 v108, v108, v112
    v_mfma_f32_32x32x16_bf16 v[32:47], a[12:15], v[84:87], v[32:47]
    buffer_load_dwordx4 v1, s[4:7], s58 offen offset:1024 sc1 lds
    ds_read_b128 v[84:87], v2 offset:28672
    s_waitcnt lgkmcnt(3)
    v_mfma_f32_32x32x16_bf16 v[16:31], a[16:19], v[88:91], v[16:31]
    v_add_f32 v101, v101, v105
    v_add_f32 v109, v109, v113
    v_add_f32 v100, v100, v108
    v_add_f32 v101, v101, v109
    v_mfma_f32_32x32x16_bf16 v[32:47], a[20:23], v[88:91], v[32:47]
    buffer_load_dwordx4 v1, s[4:7], s58 offen offset:2048 sc1 lds
    ds_read_b128 v[88:91], v2 offset:29696
    s_waitcnt lgkmcnt(3)
    v_mfma_f32_32x32x16_bf16 v[16:31], a[24:27], v[92:95], v[16:31]
    v_mov_b32 v10, v100
    v_mov_b32 v11, v101
    s_nop 0
    v_permlane32_swap_b32 v10, v100
    v_permlane32_swap_b32 v11, v101
    v_mfma_f32_32x32x16_bf16 v[32:47], a[28:31], v[92:95], v[32:47]
    buffer_load_dwordx4 v1, s[4:7], s58 offen offset:3072 sc1 lds
    s_add_u32 s58, s58, 4096
    s_add_u32 s59, s59, 4096
    ds_read_b128 v[92:95], v2 offset:30720
    s_waitcnt lgkmcnt(3)
    v_mfma_f32_32x32x16_bf16 v[16:31], a[32:35], v[80:83], v[16:31]
    v_add_f32 v100, v100, v10
    v_add_f32 v101, v101, v11
    v_mul_f32 v99, 0x3b124925, v100
    v_mul_f32 v11, 0x3b124925, v101
    v_mfma_f32_32x32x16_bf16 v[32:47], a[36:39], v[80:83], v[32:47]
    s_mov_b32 m0, s59
    s_nop 0
    buffer_load_dwordx4 v1, s[4:7], s58 offen sc1 lds
    ds_read_b128 v[80:83], v2 offset:31744
    s_waitcnt lgkmcnt(3)
    v_mfma_f32_32x32x16_bf16 v[16:31], a[40:43], v[84:87], v[16:31]
    v_mul_f32 v10, v99, v99
    v_sub_f32 v8, v11, v10
    v_max_f32 v8, 0, v8
    v_add_f32 v8, 0x3727c5ac, v8
    v_mfma_f32_32x32x16_bf16 v[32:47], a[44:47], v[84:87], v[32:47]
    buffer_load_dwordx4 v1, s[4:7], s58 offen offset:1024 sc1 lds
    ds_read_b128 v[84:87], v2 offset:32768
    s_waitcnt lgkmcnt(3)
    v_mfma_f32_32x32x16_bf16 v[16:31], a[48:51], v[88:91], v[16:31]
    v_rsq_f32 v9, v8
    v_lshrrev_b32 v12, 1, v4
    s_mul_i32 s20, s14, 384
    s_add_u32 s20, s20, 146432
    v_add_u32 v14, s20, v12
    v_mfma_f32_32x32x16_bf16 v[32:47], a[52:55], v[88:91], v[32:47]
    buffer_load_dwordx4 v1, s[4:7], s58 offen offset:2048 sc1 lds
    ds_read_b128 v[88:91], v2 offset:33792
    s_waitcnt lgkmcnt(3)
    v_mfma_f32_32x32x16_bf16 v[16:31], a[56:59], v[92:95], v[16:31]
    v_mul_f32 v10, v9, v9
    v_mul_f32 v11, 0xc0135761, v9
    v_mul_f32 v10, v10, v9
    v_mul_f32 v10, 0xbdd2d3e8, v10
    v_mfma_f32_32x32x16_bf16 v[32:47], a[60:63], v[92:95], v[32:47]
    buffer_load_dwordx4 v[128:131], v1, s[4:7], s88 offen
    ds_read_b128 v[92:95], v2 offset:34816
    s_waitcnt lgkmcnt(3)
    v_mfma_f32_32x32x16_bf16 v[16:31], a[64:67], v[80:83], v[16:31]
    ds_write_b32 v14, v11
    ds_write_b32 v14, v10 offset:128
    v_mfma_f32_32x32x16_bf16 v[32:47], a[68:71], v[80:83], v[32:47]
    buffer_load_dwordx4 v[132:135], v1, s[4:7], s89 offen
    ds_read_b128 v[80:83], v2 offset:35840
    s_waitcnt lgkmcnt(5)
    v_mfma_f32_32x32x16_bf16 v[16:31], a[72:75], v[84:87], v[16:31]
    ds_write_b32 v14, v8 offset:256
    s_mul_i32 s20, s31, 384
    s_add_u32 s20, s20, 146432
    s_mul_i32 s21, s31, 384
    s_sub_u32 s21, 147200, s21
    v_add_u32 v14, s21, v12
    v_add_u32 v12, s20, v12
    v_mfma_f32_32x32x16_bf16 v[32:47], a[76:79], v[84:87], v[32:47]
    buffer_load_dwordx4 v[136:139], v1, s[4:7], s88 offen offset:1024
    ds_read_b128 v[84:87], v2 offset:36864
    s_waitcnt lgkmcnt(6)
    v_mfma_f32_32x32x16_bf16 v[16:31], a[80:83], v[88:91], v[16:31]
    v_cvt_pk_bf16_f32 v10, -v99, -v99
    v_and_b32 v125, 0xffff0000, v10
    v_add_f32 v125, v125, v99
    v_mov_b32 v126, 0
    v_mfma_f32_32x32x16_bf16 v[32:47], a[84:87], v[88:91], v[32:47]
    buffer_load_dwordx4 v[140:143], v1, s[4:7], s89 offen offset:1024
    ds_read_b128 v[88:91], v2 offset:37888
    s_waitcnt lgkmcnt(6)
    v_mfma_f32_32x32x16_bf16 v[16:31], a[88:91], v[92:95], v[16:31]
    v_mov_b32 v127, 0
    v_cvt_pk_bf16_f32 v125, -v125, -v125
    v_cndmask_b32 v124, v10, v126, s[26:27]
    v_cndmask_b32 v125, v125, v126, s[26:27]
    s_lshl_b32 s20, s14, 10
    s_add_u32 s20, s20, 148480
    v_mfma_f32_32x32x16_bf16 v[32:47], a[92:95], v[92:95], v[32:47]
    buffer_load_dwordx4 v[144:147], v1, s[4:7], s88 offen offset:2048
    ds_read_b128 v[92:95], v2 offset:38912
    s_waitcnt lgkmcnt(4)
    v_mfma_f32_32x32x16_bf16 v[16:31], a[96:99], v[80:83], v[16:31]
    v_add_u32 v11, s20, v1
    ds_write_b128 v11, v[124:127]
    s_lshl_b32 s20, s31, 10
    s_add_u32 s20, s20, 148480
    v_add_u32 v108, s20, v1
    s_lshl_b32 s21, s31, 10
    s_sub_u32 s21, 150528, s21
    v_mfma_f32_32x32x16_bf16 v[32:47], a[100:103], v[80:83], v[32:47]
    buffer_load_dwordx4 v[148:151], v1, s[4:7], s89 offen offset:2048
    ds_read_b128 v[80:83], v2 offset:39936
    s_waitcnt lgkmcnt(4)
    v_mfma_f32_32x32x16_bf16 v[16:31], a[104:107], v[84:87], v[16:31]
    v_add_u32 v109, s21, v1
    v_mfma_f32_32x32x16_bf16 v[32:47], a[108:111], v[84:87], v[32:47]
    buffer_load_dwordx4 v[152:155], v1, s[4:7], s88 offen offset:3072
    ds_read_b128 v[84:87], v2 offset:40960
    s_waitcnt lgkmcnt(4)
    v_mfma_f32_32x32x16_bf16 v[16:31], a[112:115], v[88:91], v[16:31]
    v_mfma_f32_32x32x16_bf16 v[32:47], a[116:119], v[88:91], v[32:47]
    buffer_load_dwordx4 v[156:159], v1, s[4:7], s89 offen offset:3072
    ds_read_b128 v[88:91], v2 offset:41984
    s_waitcnt lgkmcnt(4)
    v_mfma_f32_32x32x16_bf16 v[16:31], a[120:123], v[92:95], v[16:31]
    v_mfma_f32_32x32x16_bf16 v[32:47], a[124:127], v[92:95], v[32:47]
    s_add_u32 s88, s88, 4096
    buffer_load_dwordx4 v[160:163], v1, s[4:7], s88 offen
    ds_read_b128 v[92:95], v2 offset:43008
    s_waitcnt lgkmcnt(3)
    v_mfma_f32_32x32x16_bf16 v[16:31], a[128:131], v[80:83], v[16:31]
    v_mfma_f32_32x32x16_bf16 v[32:47], a[132:135], v[80:83], v[32:47]
    s_add_u32 s89, s89, 4096
    buffer_load_dwordx4 v[164:167], v1, s[4:7], s89 offen
    ds_read_b128 v[80:83], v2 offset:44032
    s_waitcnt lgkmcnt(3)
    v_mfma_f32_32x32x16_bf16 v[16:31], a[136:139], v[84:87], v[16:31]
    v_mfma_f32_32x32x16_bf16 v[32:47], a[140:143], v[84:87], v[32:47]
    buffer_load_dwordx4 v[168:171], v1, s[4:7], s88 offen offset:1024
    ds_read_b128 v[84:87], v2 offset:45056
    s_waitcnt lgkmcnt(3)
    v_mfma_f32_32x32x16_bf16 v[16:31], a[144:147], v[88:91], v[16:31]
    v_mfma_f32_32x32x16_bf16 v[32:47], a[148:151], v[88:91], v[32:47]
    buffer_load_dwordx4 v[172:175], v1, s[4:7], s89 offen offset:1024
    ds_read_b128 v[88:91], v2 offset:46080
    s_waitcnt lgkmcnt(3)
    v_mfma_f32_32x32x16_bf16 v[16:31], a[152:155], v[92:95], v[16:31]
    v_mfma_f32_32x32x16_bf16 v[32:47], a[156:159], v[92:95], v[32:47]
    ds_read_b128 v[92:95], v2 offset:47104
    s_waitcnt lgkmcnt(3)
    v_mfma_f32_32x32x16_bf16 v[16:31], a[160:163], v[80:83], v[16:31]
    v_mfma_f32_32x32x16_bf16 v[32:47], a[164:167], v[80:83], v[32:47]
    ds_read_b128 v[80:83], v2 offset:48128
    s_waitcnt lgkmcnt(3)
    v_mfma_f32_32x32x16_bf16 v[16:31], a[168:171], v[84:87], v[16:31]
    v_mfma_f32_32x32x16_bf16 v[32:47], a[172:175], v[84:87], v[32:47]
    ds_read_b128 v[84:87], v2 offset:49152
    s_waitcnt lgkmcnt(3)
    v_mfma_f32_32x32x16_bf16 v[16:31], a[176:179], v[88:91], v[16:31]
    v_mfma_f32_32x32x16_bf16 v[32:47], a[180:183], v[88:91], v[32:47]
    ds_read_b128 v[88:91], v2 offset:50176
    s_waitcnt lgkmcnt(3)
    v_mfma_f32_32x32x16_bf16 v[16:31], a[184:187], v[92:95], v[16:31]
    v_mfma_f32_32x32x16_bf16 v[32:47], a[188:191], v[92:95], v[32:47]
    s_waitcnt vmcnt(12)
    s_barrier
    ds_read_b128 v[92:95], v2 offset:51200
    s_waitcnt lgkmcnt(3)
    v_mfma_f32_32x32x16_bf16 v[16:31], a[192:195], v[80:83], v[16:31]
    v_mfma_f32_32x32x16_bf16 v[32:47], a[196:199], v[80:83], v[32:47]
    ds_read_b128 v[80:83], v108 offset:0
    s_waitcnt lgkmcnt(3)
    v_mfma_f32_32x32x16_bf16 v[16:31], a[200:203], v[84:87], v[16:31]
    v_mfma_f32_32x32x16_bf16 v[32:47], a[204:207], v[84:87], v[32:47]
    ds_read_b128 v[84:87], v13 offset:0
    s_waitcnt lgkmcnt(3)
    v_mfma_f32_32x32x16_bf16 v[16:31], a[208:211], v[88:91], v[16:31]
    v_mfma_f32_32x32x16_bf16 v[32:47], a[212:215], v[88:91], v[32:47]
    ds_read_b128 v[88:91], v13 offset:1024
    s_waitcnt lgkmcnt(3)
    v_mfma_f32_32x32x16_bf16 v[16:31], a[216:219], v[92:95], v[16:31]
    v_mfma_f32_32x32x16_bf16 v[32:47], a[220:223], v[92:95], v[32:47]
    ds_read_b128 v[92:95], v13 offset:2048
    s_waitcnt lgkmcnt(3)
    v_mfma_f32_32x32x16_bf16 v[16:31], a[224:227], v[80:83], v[16:31]
    v_mfma_f32_32x32x16_bf16 v[32:47], a[228:231], v[80:83], v[32:47]
    ds_read_b128 v[80:83], v13 offset:3072
    s_waitcnt lgkmcnt(3)
    v_mfma_f32_32x32x16_bf16 v[48:63], a[0:3], v[84:87], 0
    v_mfma_f32_32x32x16_bf16 v[64:79], a[4:7], v[84:87], 0
    s_barrier
    ds_read_b128 v[84:87], v13 offset:4096
    s_waitcnt lgkmcnt(3)
    v_mfma_f32_32x32x16_bf16 v[48:63], a[8:11], v[88:91], v[48:63]
    v_mfma_f32_32x32x16_bf16 v[64:79], a[12:15], v[88:91], v[64:79]
    s_mov_b32 m0, s61
    s_nop 0
    buffer_load_dwordx4 v1, s[4:7], s60 offen sc1 lds
    ds_read_b128 v[88:91], v13 offset:5120
    s_waitcnt lgkmcnt(3)
    v_mfma_f32_32x32x16_bf16 v[48:63], a[16:19], v[92:95], v[48:63]
    ds_read_b32 v96, v12 offset:0
    ds_read_b32 v97, v12 offset:128
    ds_read_b32 v98, v12 offset:256
    s_xor_b32 s20, s31, 0
    s_mul_i32 s34, s20, 114688
    s_mul_i32 s23, s12, 458752
    s_add_u32 s34, s34, s23
    s_lshl_b32 s23, s29, 13
    s_add_u32 s34, s34, s23
    s_lshl_b32 s23, s14, 11
    s_add_u32 s34, s34, s23
    s_mul_i32 s23, s15, 7340032
    s_add_u32 s34, s34, s23
    s_add_u32 s34, s34, 21397504
    v_mfma_f32_32x32x16_bf16 v[64:79], a[20:23], v[92:95], v[64:79]
    buffer_load_dwordx4 v1, s[4:7], s60 offen offset:1024 sc1 lds
    ds_read_b128 v[92:95], v13 offset:6144
    s_waitcnt lgkmcnt(6)
    v_mfma_f32_32x32x16_bf16 v[48:63], a[24:27], v[80:83], v[48:63]
    v_mul_f32 v100, v16, v16
    v_mul_f32 v101, v17, v17
    v_mul_f32 v102, v18, v18
    v_mul_f32 v103, v19, v19
    v_mul_f32 v104, v16, v32
    v_mfma_f32_32x32x16_bf16 v[64:79], a[28:31], v[80:83], v[64:79]
    buffer_load_dwordx4 v1, s[4:7], s60 offen offset:2048 sc1 lds
    ds_read_b128 v[80:83], v13 offset:7168
    s_waitcnt lgkmcnt(6)
    v_mfma_f32_32x32x16_bf16 v[48:63], a[32:35], v[84:87], v[48:63]
    v_mul_f32 v105, v17, v33
    v_mul_f32 v106, v18, v34
    v_mul_f32 v107, v19, v35
    s_waitcnt lgkmcnt(2)
    v_fma_f32 v100, v100, v97, v96
    v_fma_f32 v101, v101, v97, v96
    v_mfma_f32_32x32x16_bf16 v[64:79], a[36:39], v[84:87], v[64:79]
    buffer_load_dwordx4 v1, s[4:7], s60 offen offset:3072 sc1 lds
    s_add_u32 s60, s60, 4096
    s_add_u32 s61, s61, 4096
    ds_read_b128 v[84:87], v13 offset:8192
    v_mfma_f32_32x32x16_bf16 v[48:63], a[40:43], v[88:91], v[48:63]
    v_fma_f32 v102, v102, v97, v96
    v_fma_f32 v103, v103, v97, v96
    v_mul_f32 v100, v100, v16
    v_mul_f32 v101, v101, v17
    v_mul_f32 v102, v102, v18
    v_mfma_f32_32x32x16_bf16 v[64:79], a[44:47], v[88:91], v[64:79]
    s_mov_b32 m0, s61
    s_nop 0
    buffer_load_dwordx4 v1, s[4:7], s60 offen sc1 lds
    ds_read_b128 v[88:91], v13 offset:9216
    s_waitcnt lgkmcnt(3)
    v_mfma_f32_32x32x16_bf16 v[48:63], a[48:51], v[92:95], v[48:63]
    v_mul_f32 v103, v103, v19
    v_exp_f32 v100, v100
    v_exp_f32 v101, v101
    v_mfma_f32_32x32x16_bf16 v[64:79], a[52:55], v[92:95], v[64:79]
    buffer_load_dwordx4 v1, s[4:7], s60 offen offset:1024 sc1 lds
    ds_read_b128 v[92:95], v13 offset:10240
    s_waitcnt lgkmcnt(3)
    v_mfma_f32_32x32x16_bf16 v[48:63], a[56:59], v[80:83], v[48:63]
    v_exp_f32 v102, v102
    v_exp_f32 v103, v103
    v_fma_f32 v100, v100, v98, v98
    v_fma_f32 v101, v101, v98, v98
    v_mfma_f32_32x32x16_bf16 v[64:79], a[60:63], v[80:83], v[64:79]
    buffer_load_dwordx4 v1, s[4:7], s60 offen offset:2048 sc1 lds
    ds_read_b128 v[80:83], v13 offset:11264
    s_waitcnt lgkmcnt(3)
    v_mfma_f32_32x32x16_bf16 v[48:63], a[64:67], v[84:87], v[48:63]
    v_fma_f32 v102, v102, v98, v98
    v_fma_f32 v103, v103, v98, v98
    v_rcp_f32 v100, v100
    v_rcp_f32 v101, v101
    v_mfma_f32_32x32x16_bf16 v[64:79], a[68:71], v[84:87], v[64:79]
    buffer_load_dwordx4 v[176:179], v1, s[4:7], s88 offen offset:2048
    ds_read_b128 v[84:87], v13 offset:12288
    s_waitcnt lgkmcnt(3)
    v_mfma_f32_32x32x16_bf16 v[48:63], a[72:75], v[88:91], v[48:63]
    v_rcp_f32 v102, v102
    v_rcp_f32 v103, v103
    v_mul_f32 v104, v104, v100
    v_mul_f32 v105, v105, v101
    v_mfma_f32_32x32x16_bf16 v[64:79], a[76:79], v[88:91], v[64:79]
    buffer_load_dwordx4 v[180:183], v1, s[4:7], s89 offen offset:2048
    ds_read_b128 v[88:91], v13 offset:13312
    s_waitcnt lgkmcnt(3)
    v_mfma_f32_32x32x16_bf16 v[48:63], a[80:83], v[92:95], v[48:63]
    v_mul_f32 v106, v106, v102
    v_mul_f32 v107, v107, v103
    v_cvt_pk_bf16_f32 v116, v104, v105
    v_cvt_pk_bf16_f32 v117, v106, v107
    v_mul_f32 v100, v20, v20
    v_mfma_f32_32x32x16_bf16 v[64:79], a[84:87], v[92:95], v[64:79]
    buffer_load_dwordx4 v[184:187], v1, s[4:7], s88 offen offset:3072
    ds_read_b128 v[92:95], v13 offset:14336
    s_waitcnt lgkmcnt(3)
    v_mfma_f32_32x32x16_bf16 v[48:63], a[88:91], v[80:83], v[48:63]
    v_mul_f32 v101, v21, v21
    v_mul_f32 v102, v22, v22
    v_mul_f32 v103, v23, v23
    v_mul_f32 v104, v20, v36
    v_mul_f32 v105, v21, v37
    v_mfma_f32_32x32x16_bf16 v[64:79], a[92:95], v[80:83], v[64:79]
    buffer_load_dwordx4 v[188:191], v1, s[4:7], s89 offen offset:3072
    ds_read_b128 v[80:83], v13 offset:15360
    s_waitcnt lgkmcnt(3)
    v_mfma_f32_32x32x16_bf16 v[48:63], a[96:99], v[84:87], v[48:63]
    v_mul_f32 v106, v22, v38
    v_mul_f32 v107, v23, v39
    v_fma_f32 v100, v100, v97, v96
    v_fma_f32 v101, v101, v97, v96
    v_fma_f32 v102, v102, v97, v96
    v_mfma_f32_32x32x16_bf16 v[64:79], a[100:103], v[84:87], v[64:79]
    s_add_u32 s88, s88, 4096
    buffer_load_dwordx4 v[192:195], v1, s[4:7], s88 offen
    ds_read_b128 v[84:87], v13 offset:16384
    s_waitcnt lgkmcnt(3)
    v_mfma_f32_32x32x16_bf16 v[48:63], a[104:107], v[88:91], v[48:63]
    v_fma_f32 v103, v103, v97, v96
    v_mul_f32 v100, v100, v20
    v_mul_f32 v101, v101, v21
    v_mul_f32 v102, v102, v22
    v_mul_f32 v103, v103, v23
    v_mfma_f32_32x32x16_bf16 v[64:79], a[108:111], v[88:91], v[64:79]
    s_add_u32 s89, s89, 4096
    buffer_load_dwordx4 v[196:199], v1, s[4:7], s89 offen
    ds_read_b128 v[88:91], v13 offset:17408
    s_waitcnt lgkmcnt(3)
    v_mfma_f32_32x32x16_bf16 v[48:63], a[112:115], v[92:95], v[48:63]
    v_exp_f32 v100, v100
    v_exp_f32 v101, v101
    v_exp_f32 v102, v102
    v_mfma_f32_32x32x16_bf16 v[64:79], a[116:119], v[92:95], v[64:79]
    buffer_load_dwordx4 v[200:203], v1, s[4:7], s88 offen offset:1024
    ds_read_b128 v[92:95], v13 offset:18432
    s_waitcnt lgkmcnt(3)
    v_mfma_f32_32x32x16_bf16 v[48:63], a[120:123], v[80:83], v[48:63]
    v_exp_f32 v103, v103
    v_fma_f32 v100, v100, v98, v98
    v_fma_f32 v101, v101, v98, v98
    v_fma_f32 v102, v102, v98, v98
    v_fma_f32 v103, v103, v98, v98
    v_mfma_f32_32x32x16_bf16 v[64:79], a[124:127], v[80:83], v[64:79]
    buffer_load_dwordx4 v[204:207], v1, s[4:7], s89 offen offset:1024
    ds_read_b128 v[80:83], v13 offset:19456
    s_waitcnt lgkmcnt(3)
    v_mfma_f32_32x32x16_bf16 v[48:63], a[128:131], v[84:87], v[48:63]
    v_rcp_f32 v100, v100
    v_rcp_f32 v101, v101
    v_rcp_f32 v102, v102
    v_mfma_f32_32x32x16_bf16 v[64:79], a[132:135], v[84:87], v[64:79]
    buffer_load_dwordx4 v[208:211], v1, s[4:7], s88 offen offset:2048
    ds_read_b128 v[84:87], v13 offset:20480
    s_waitcnt lgkmcnt(3)
    v_mfma_f32_32x32x16_bf16 v[48:63], a[136:139], v[88:91], v[48:63]
    v_rcp_f32 v103, v103
    v_mul_f32 v104, v104, v100
    v_mul_f32 v105, v105, v101
    v_mul_f32 v106, v106, v102
    v_mul_f32 v107, v107, v103
    v_mfma_f32_32x32x16_bf16 v[64:79], a[140:143], v[88:91], v[64:79]
    buffer_load_dwordx4 v[212:215], v1, s[4:7], s89 offen offset:2048
    ds_read_b128 v[88:91], v13 offset:21504
    s_waitcnt lgkmcnt(3)
    v_mfma_f32_32x32x16_bf16 v[48:63], a[144:147], v[92:95], v[48:63]
    v_cvt_pk_bf16_f32 v118, v104, v105
    v_cvt_pk_bf16_f32 v119, v106, v107
    buffer_store_dwordx4 v[116:119], v1, s[4:7], s34 offen sc1
    v_mul_f32 v100, v24, v24
    v_mul_f32 v101, v25, v25
    v_mfma_f32_32x32x16_bf16 v[64:79], a[148:151], v[92:95], v[64:79]
    buffer_load_dwordx4 v[216:219], v1, s[4:7], s88 offen offset:3072
    ds_read_b128 v[92:95], v13 offset:22528
    s_waitcnt lgkmcnt(3)
    v_mfma_f32_32x32x16_bf16 v[48:63], a[152:155], v[80:83], v[48:63]
    v_mul_f32 v102, v26, v26
    v_mul_f32 v103, v27, v27
    v_mul_f32 v104, v24, v40
    v_mul_f32 v105, v25, v41
    v_mul_f32 v106, v26, v42
    v_mfma_f32_32x32x16_bf16 v[64:79], a[156:159], v[80:83], v[64:79]
    buffer_load_dwordx4 v[220:223], v1, s[4:7], s89 offen offset:3072
    ds_read_b128 v[80:83], v13 offset:23552
    s_waitcnt lgkmcnt(3)
    v_mfma_f32_32x32x16_bf16 v[48:63], a[160:163], v[84:87], v[48:63]
    v_mul_f32 v107, v27, v43
    v_fma_f32 v100, v100, v97, v96
    v_fma_f32 v101, v101, v97, v96
    v_fma_f32 v102, v102, v97, v96
    v_fma_f32 v103, v103, v97, v96
    v_mfma_f32_32x32x16_bf16 v[64:79], a[164:167], v[84:87], v[64:79]
    v_mul_f32 v100, v100, v24
    v_mul_f32 v101, v101, v25
    ds_read_b128 v[84:87], v13 offset:24576
    s_waitcnt lgkmcnt(3)
    v_mfma_f32_32x32x16_bf16 v[48:63], a[168:171], v[88:91], v[48:63]
    v_mul_f32 v102, v102, v26
    v_mul_f32 v103, v103, v27
    v_exp_f32 v100, v100
    v_exp_f32 v101, v101
    v_mfma_f32_32x32x16_bf16 v[64:79], a[172:175], v[88:91], v[64:79]
    v_exp_f32 v102, v102
    ds_read_b128 v[88:91], v13 offset:25600
    s_waitcnt lgkmcnt(3)
    v_mfma_f32_32x32x16_bf16 v[48:63], a[176:179], v[92:95], v[48:63]
    v_exp_f32 v103, v103
    v_fma_f32 v100, v100, v98, v98
    v_fma_f32 v101, v101, v98, v98
    v_fma_f32 v102, v102, v98, v98
    v_fma_f32 v103, v103, v98, v98
    v_mfma_f32_32x32x16_bf16 v[64:79], a[180:183], v[92:95], v[64:79]
    v_rcp_f32 v100, v100
    ds_read_b128 v[92:95], v13 offset:26624
    s_waitcnt lgkmcnt(3)
    v_mfma_f32_32x32x16_bf16 v[48:63], a[184:187], v[80:83], v[48:63]
    v_rcp_f32 v101, v101
    v_rcp_f32 v102, v102
    v_rcp_f32 v103, v103
    v_mfma_f32_32x32x16_bf16 v[64:79], a[188:191], v[80:83], v[64:79]
    v_mul_f32 v104, v104, v100
    v_mul_f32 v105, v105, v101
    s_waitcnt vmcnt(13)
    s_barrier
    ds_read_b128 v[80:83], v13 offset:27648
    s_waitcnt lgkmcnt(3)
    v_mfma_f32_32x32x16_bf16 v[48:63], a[192:195], v[84:87], v[48:63]
    v_mul_f32 v106, v106, v102
    v_mul_f32 v107, v107, v103
    v_cvt_pk_bf16_f32 v120, v104, v105
    v_cvt_pk_bf16_f32 v121, v106, v107
    v_mul_f32 v100, v28, v28
    v_mfma_f32_32x32x16_bf16 v[64:79], a[196:199], v[84:87], v[64:79]
    v_mul_f32 v101, v29, v29
    v_mul_f32 v102, v30, v30
    ds_read_b128 v[84:87], v108 offset:1024
    s_waitcnt lgkmcnt(3)
    v_mfma_f32_32x32x16_bf16 v[48:63], a[200:203], v[88:91], v[48:63]
    v_mul_f32 v103, v31, v31
    v_mul_f32 v104, v28, v44
    v_mul_f32 v105, v29, v45
    v_mul_f32 v106, v30, v46
    v_mul_f32 v107, v31, v47
    v_mfma_f32_32x32x16_bf16 v[64:79], a[204:207], v[88:91], v[64:79]
    v_fma_f32 v100, v100, v97, v96
    v_fma_f32 v101, v101, v97, v96
    ds_read_b128 v[88:91], v2 offset:23552
    s_waitcnt lgkmcnt(3)
    v_mfma_f32_32x32x16_bf16 v[48:63], a[208:211], v[92:95], v[48:63]
    v_fma_f32 v102, v102, v97, v96
    v_fma_f32 v103, v103, v97, v96
    v_mul_f32 v100, v100, v28
    v_mul_f32 v101, v101, v29
    v_mul_f32 v102, v102, v30
    v_mfma_f32_32x32x16_bf16 v[64:79], a[212:215], v[92:95], v[64:79]
    v_mul_f32 v103, v103, v31
    ds_read_b128 v[92:95], v2 offset:24576
    s_waitcnt lgkmcnt(3)
    v_mfma_f32_32x32x16_bf16 v[48:63], a[216:219], v[80:83], v[48:63]
    v_exp_f32 v100, v100
    v_exp_f32 v101, v101
    v_exp_f32 v102, v102
    v_mfma_f32_32x32x16_bf16 v[64:79], a[220:223], v[80:83], v[64:79]
    v_exp_f32 v103, v103
    ds_read_b128 v[80:83], v2 offset:25600
    s_waitcnt lgkmcnt(3)
    v_mfma_f32_32x32x16_bf16 v[48:63], a[224:227], v[84:87], v[48:63]
    v_fma_f32 v100, v100, v98, v98
    v_fma_f32 v101, v101, v98, v98
    v_fma_f32 v102, v102, v98, v98
    v_fma_f32 v103, v103, v98, v98
    v_rcp_f32 v100, v100
    v_mfma_f32_32x32x16_bf16 v[64:79], a[228:231], v[84:87], v[64:79]
    v_rcp_f32 v101, v101
    v_rcp_f32 v102, v102
    v_rcp_f32 v103, v103
    v_mul_f32 v104, v104, v100
    v_mul_f32 v105, v105, v101
    v_mul_f32 v106, v106, v102
    v_mul_f32 v107, v107, v103
    v_cvt_pk_bf16_f32 v122, v104, v105
    v_cvt_pk_bf16_f32 v123, v106, v107
    buffer_store_dwordx4 v[120:123], v1, s[4:7], s34 offen offset:1024 sc1
    ds_read_b128 v[84:87], v2 offset:26624
    s_waitcnt lgkmcnt(3)
    v_mfma_f32_32x32x16_bf16 v[16:31], a[0:3], v[88:91], 0
    v_mfma_f32_32x32x16_bf16 v[32:47], a[4:7], v[88:91], 0
    s_barrier
    ds_read_b128 v[88:91], v2 offset:27648
    s_waitcnt lgkmcnt(3)
    v_mfma_f32_32x32x16_bf16 v[16:31], a[8:11], v[92:95], v[16:31]
    v_mfma_f32_32x32x16_bf16 v[32:47], a[12:15], v[92:95], v[32:47]
    s_mov_b32 m0, s63
    s_nop 0
    buffer_load_dwordx4 v1, s[4:7], s62 offen sc1 lds
    ds_read_b128 v[92:95], v2 offset:28672
    s_waitcnt lgkmcnt(3)
    v_mfma_f32_32x32x16_bf16 v[16:31], a[16:19], v[80:83], v[16:31]
    ds_read_b32 v96, v12 offset:384
    ds_read_b32 v97, v12 offset:512
    ds_read_b32 v98, v12 offset:640
    s_xor_b32 s20, s31, 1
    s_mul_i32 s34, s20, 114688
    s_mul_i32 s23, s12, 458752
    s_add_u32 s34, s34, s23
    s_lshl_b32 s23, s29, 13
    s_add_u32 s34, s34, s23
    s_lshl_b32 s23, s14, 11
    s_add_u32 s34, s34, s23
    s_mul_i32 s23, s15, 7340032
    s_add_u32 s34, s34, s23
    s_add_u32 s34, s34, 21397504
    v_mfma_f32_32x32x16_bf16 v[32:47], a[20:23], v[80:83], v[32:47]
    buffer_load_dwordx4 v1, s[4:7], s62 offen offset:1024 sc1 lds
    ds_read_b128 v[80:83], v2 offset:29696
    s_waitcnt lgkmcnt(6)
    v_mfma_f32_32x32x16_bf16 v[16:31], a[24:27], v[84:87], v[16:31]
    v_mul_f32 v100, v48, v48
    v_mul_f32 v101, v49, v49
    v_mul_f32 v102, v50, v50
    v_mul_f32 v103, v51, v51
    v_mul_f32 v104, v48, v64
    v_mfma_f32_32x32x16_bf16 v[32:47], a[28:31], v[84:87], v[32:47]
    buffer_load_dwordx4 v1, s[4:7], s62 offen offset:2048 sc1 lds
    ds_read_b128 v[84:87], v2 offset:30720
    s_waitcnt lgkmcnt(6)
    v_mfma_f32_32x32x16_bf16 v[16:31], a[32:35], v[88:91], v[16:31]
    v_mul_f32 v105, v49, v65
    v_mul_f32 v106, v50, v66
    v_mul_f32 v107, v51, v67
    s_waitcnt lgkmcnt(2)
    v_fma_f32 v100, v100, v97, v96
    v_fma_f32 v101, v101, v97, v96
    v_mfma_f32_32x32x16_bf16 v[32:47], a[36:39], v[88:91], v[32:47]
    buffer_load_dwordx4 v1, s[4:7], s62 offen offset:3072 sc1 lds
    s_add_u32 s62, s62, 4096
    s_add_u32 s63, s63, 4096
    ds_read_b128 v[88:91], v2 offset:31744
    v_mfma_f32_32x32x16_bf16 v[16:31], a[40:43], v[92:95], v[16:31]
    v_fma_f32 v102, v102, v97, v96
    v_fma_f32 v103, v103, v97, v96
    v_mul_f32 v100, v100, v48
    v_mul_f32 v101, v101, v49
    v_mul_f32 v102, v102, v50
    v_mfma_f32_32x32x16_bf16 v[32:47], a[44:47], v[92:95], v[32:47]
    s_mov_b32 m0, s63
    s_nop 0
    buffer_load_dwordx4 v1, s[4:7], s62 offen sc1 lds
    ds_read_b128 v[92:95], v2 offset:32768
    s_waitcnt lgkmcnt(3)
    v_mfma_f32_32x32x16_bf16 v[16:31], a[48:51], v[80:83], v[16:31]
    v_mul_f32 v103, v103, v51
    v_exp_f32 v100, v100
    v_exp_f32 v101, v101
    v_mfma_f32_32x32x16_bf16 v[32:47], a[52:55], v[80:83], v[32:47]
    buffer_load_dwordx4 v1, s[4:7], s62 offen offset:1024 sc1 lds
    ds_read_b128 v[80:83], v2 offset:33792
    s_waitcnt lgkmcnt(3)
    v_mfma_f32_32x32x16_bf16 v[16:31], a[56:59], v[84:87], v[16:31]
    v_exp_f32 v102, v102
    v_exp_f32 v103, v103
    v_fma_f32 v100, v100, v98, v98
    v_fma_f32 v101, v101, v98, v98
    v_mfma_f32_32x32x16_bf16 v[32:47], a[60:63], v[84:87], v[32:47]
    buffer_load_dwordx4 v1, s[4:7], s62 offen offset:2048 sc1 lds
    ds_read_b128 v[84:87], v2 offset:34816
    s_waitcnt lgkmcnt(3)
    v_mfma_f32_32x32x16_bf16 v[16:31], a[64:67], v[88:91], v[16:31]
    v_fma_f32 v102, v102, v98, v98
    v_fma_f32 v103, v103, v98, v98
    v_rcp_f32 v100, v100
    v_rcp_f32 v101, v101
    v_mfma_f32_32x32x16_bf16 v[32:47], a[68:71], v[88:91], v[32:47]
    s_add_u32 s88, s88, 4096
    buffer_load_dwordx4 v[224:227], v1, s[4:7], s88 offen
    ds_read_b128 v[88:91], v2 offset:35840
    s_waitcnt lgkmcnt(3)
    v_mfma_f32_32x32x16_bf16 v[16:31], a[72:75], v[92:95], v[16:31]
    v_rcp_f32 v102, v102
    v_rcp_f32 v103, v103
    v_mul_f32 v104, v104, v100
    v_mul_f32 v105, v105, v101
    v_mfma_f32_32x32x16_bf16 v[32:47], a[76:79], v[92:95], v[32:47]
    s_add_u32 s89, s89, 4096
    buffer_load_dwordx4 v[228:231], v1, s[4:7], s89 offen
    ds_read_b128 v[92:95], v2 offset:36864
    s_waitcnt lgkmcnt(3)
    v_mfma_f32_32x32x16_bf16 v[16:31], a[80:83], v[80:83], v[16:31]
    v_mul_f32 v106, v106, v102
    v_mul_f32 v107, v107, v103
    v_cvt_pk_bf16_f32 v116, v104, v105
    v_cvt_pk_bf16_f32 v117, v106, v107
    v_mul_f32 v100, v52, v52
    v_mfma_f32_32x32x16_bf16 v[32:47], a[84:87], v[80:83], v[32:47]
    buffer_load_dwordx4 v[232:235], v1, s[4:7], s88 offen offset:1024
    ds_read_b128 v[80:83], v2 offset:37888
    s_waitcnt lgkmcnt(3)
    v_mfma_f32_32x32x16_bf16 v[16:31], a[88:91], v[84:87], v[16:31]
    v_mul_f32 v101, v53, v53
    v_mul_f32 v102, v54, v54
    v_mul_f32 v103, v55, v55
    v_mul_f32 v104, v52, v68
    v_mul_f32 v105, v53, v69
    v_mfma_f32_32x32x16_bf16 v[32:47], a[92:95], v[84:87], v[32:47]
    buffer_load_dwordx4 v[236:239], v1, s[4:7], s89 offen offset:1024
    ds_read_b128 v[84:87], v2 offset:38912
    s_waitcnt lgkmcnt(3)
    v_mfma_f32_32x32x16_bf16 v[16:31], a[96:99], v[88:91], v[16:31]
    v_mul_f32 v106, v54, v70
    v_mul_f32 v107, v55, v71
    v_fma_f32 v100, v100, v97, v96
    v_fma_f32 v101, v101, v97, v96
    v_fma_f32 v102, v102, v97, v96
    v_mfma_f32_32x32x16_bf16 v[32:47], a[100:103], v[88:91], v[32:47]
    buffer_load_dwordx4 v[240:243], v1, s[4:7], s90 offen
    ds_read_b128 v[88:91], v2 offset:39936
    s_waitcnt lgkmcnt(3)
    v_mfma_f32_32x32x16_bf16 v[16:31], a[104:107], v[92:95], v[16:31]
    v_fma_f32 v103, v103, v97, v96
    v_mul_f32 v100, v100, v52
    v_mul_f32 v101, v101, v53
    v_mul_f32 v102, v102, v54
    v_mul_f32 v103, v103, v55
    v_mfma_f32_32x32x16_bf16 v[32:47], a[108:111], v[92:95], v[32:47]
    buffer_load_dwordx4 v[244:247], v1, s[4:7], s91 offen
    ds_read_b128 v[92:95], v2 offset:40960
    s_waitcnt lgkmcnt(3)
    v_mfma_f32_32x32x16_bf16 v[16:31], a[112:115], v[80:83], v[16:31]
    v_exp_f32 v100, v100
    v_exp_f32 v101, v101
    v_exp_f32 v102, v102
    v_mfma_f32_32x32x16_bf16 v[32:47], a[116:119], v[80:83], v[32:47]
    buffer_load_dwordx4 v[248:251], v1, s[4:7], s90 offen offset:1024
    ds_read_b128 v[80:83], v2 offset:41984
    s_waitcnt lgkmcnt(3)
    v_mfma_f32_32x32x16_bf16 v[16:31], a[120:123], v[84:87], v[16:31]
    v_exp_f32 v103, v103
    v_fma_f32 v100, v100, v98, v98
    v_fma_f32 v101, v101, v98, v98
    v_fma_f32 v102, v102, v98, v98
    v_fma_f32 v103, v103, v98, v98
    v_mfma_f32_32x32x16_bf16 v[32:47], a[124:127], v[84:87], v[32:47]
    buffer_load_dwordx4 v[252:255], v1, s[4:7], s91 offen offset:1024
    ds_read_b128 v[84:87], v2 offset:43008
    s_waitcnt lgkmcnt(3)
    v_mfma_f32_32x32x16_bf16 v[16:31], a[128:131], v[88:91], v[16:31]
    v_rcp_f32 v100, v100
    v_rcp_f32 v101, v101
    v_rcp_f32 v102, v102
    v_mfma_f32_32x32x16_bf16 v[32:47], a[132:135], v[88:91], v[32:47]
    v_rcp_f32 v103, v103
    ds_read_b128 v[88:91], v2 offset:44032
    s_waitcnt lgkmcnt(3)
    v_mfma_f32_32x32x16_bf16 v[16:31], a[136:139], v[92:95], v[16:31]
    v_mul_f32 v104, v104, v100
    v_mul_f32 v105, v105, v101
    v_mul_f32 v106, v106, v102
    v_mul_f32 v107, v107, v103
    v_cvt_pk_bf16_f32 v118, v104, v105
    v_mfma_f32_32x32x16_bf16 v[32:47], a[140:143], v[92:95], v[32:47]
    v_cvt_pk_bf16_f32 v119, v106, v107
    ds_read_b128 v[92:95], v2 offset:45056
    s_waitcnt lgkmcnt(3)
    v_mfma_f32_32x32x16_bf16 v[16:31], a[144:147], v[80:83], v[16:31]
    buffer_store_dwordx4 v[116:119], v1, s[4:7], s34 offen sc1
    v_mul_f32 v100, v56, v56
    v_mul_f32 v101, v57, v57
    v_mul_f32 v102, v58, v58
    v_mul_f32 v103, v59, v59
    v_mfma_f32_32x32x16_bf16 v[32:47], a[148:151], v[80:83], v[32:47]
    v_mul_f32 v104, v56, v72
    v_mul_f32 v105, v57, v73
    ds_read_b128 v[80:83], v2 offset:46080
    s_waitcnt lgkmcnt(3)
    v_mfma_f32_32x32x16_bf16 v[16:31], a[152:155], v[84:87], v[16:31]
    v_mul_f32 v106, v58, v74
    v_mul_f32 v107, v59, v75
    v_fma_f32 v100, v100, v97, v96
    v_fma_f32 v101, v101, v97, v96
    v_fma_f32 v102, v102, v97, v96
    v_mfma_f32_32x32x16_bf16 v[32:47], a[156:159], v[84:87], v[32:47]
    v_fma_f32 v103, v103, v97, v96
    v_mul_f32 v100, v100, v56
    ds_read_b128 v[84:87], v2 offset:47104
    s_waitcnt lgkmcnt(3)
    v_mfma_f32_32x32x16_bf16 v[16:31], a[160:163], v[88:91], v[16:31]
    v_mul_f32 v101, v101, v57
    v_mul_f32 v102, v102, v58
    v_mul_f32 v103, v103, v59
    v_exp_f32 v100, v100
    v_mfma_f32_32x32x16_bf16 v[32:47], a[164:167], v[88:91], v[32:47]
    v_exp_f32 v101, v101
    ds_read_b128 v[88:91], v2 offset:48128
    s_waitcnt lgkmcnt(3)
    v_mfma_f32_32x32x16_bf16 v[16:31], a[168:171], v[92:95], v[16:31]
    v_exp_f32 v102, v102
    v_exp_f32 v103, v103
    v_fma_f32 v100, v100, v98, v98
    v_fma_f32 v101, v101, v98, v98
    v_mfma_f32_32x32x16_bf16 v[32:47], a[172:175], v[92:95], v[32:47]
    v_fma_f32 v102, v102, v98, v98
    v_fma_f32 v103, v103, v98, v98
    ds_read_b128 v[92:95], v2 offset:49152
    s_waitcnt lgkmcnt(3)
    v_mfma_f32_32x32x16_bf16 v[16:31], a[176:179], v[80:83], v[16:31]
    v_rcp_f32 v100, v100
    v_rcp_f32 v101, v101
    v_rcp_f32 v102, v102
    v_mfma_f32_32x32x16_bf16 v[32:47], a[180:183], v[80:83], v[32:47]
    v_rcp_f32 v103, v103
    ds_read_b128 v[80:83], v2 offset:50176
    s_waitcnt lgkmcnt(3)
    v_mfma_f32_32x32x16_bf16 v[16:31], a[184:187], v[84:87], v[16:31]
    v_mul_f32 v104, v104, v100
    v_mul_f32 v105, v105, v101
    v_mul_f32 v106, v106, v102
    v_mul_f32 v107, v107, v103
    v_cvt_pk_bf16_f32 v120, v104, v105
    v_mfma_f32_32x32x16_bf16 v[32:47], a[188:191], v[84:87], v[32:47]
    v_cvt_pk_bf16_f32 v121, v106, v107
    v_mul_f32 v100, v60, v60
    s_waitcnt vmcnt(9)
    s_barrier
    ds_read_b128 v[84:87], v2 offset:51200
    s_waitcnt lgkmcnt(3)
    v_mfma_f32_32x32x16_bf16 v[16:31], a[192:195], v[88:91], v[16:31]
    v_mul_f32 v101, v61, v61
    v_mul_f32 v102, v62, v62
    v_mul_f32 v103, v63, v63
    v_mul_f32 v104, v60, v76
    v_mul_f32 v105, v61, v77
    v_mfma_f32_32x32x16_bf16 v[32:47], a[196:199], v[88:91], v[32:47]
    v_mul_f32 v106, v62, v78
    v_mul_f32 v107, v63, v79
    ds_read_b128 v[88:91], v109 offset:0
    s_waitcnt lgkmcnt(3)
    v_mfma_f32_32x32x16_bf16 v[16:31], a[200:203], v[92:95], v[16:31]
    v_fma_f32 v100, v100, v97, v96
    v_fma_f32 v101, v101, v97, v96
    v_fma_f32 v102, v102, v97, v96
    v_fma_f32 v103, v103, v97, v96
    v_mul_f32 v100, v100, v60
    v_mfma_f32_32x32x16_bf16 v[32:47], a[204:207], v[92:95], v[32:47]
    v_mul_f32 v101, v101, v61
    v_mul_f32 v102, v102, v62
    ds_read_b128 v[92:95], v13 offset:0
    s_waitcnt lgkmcnt(3)
    v_mfma_f32_32x32x16_bf16 v[16:31], a[208:211], v[80:83], v[16:31]
    v_mul_f32 v103, v103, v63
    v_exp_f32 v100, v100
    v_exp_f32 v101, v101
    v_mfma_f32_32x32x16_bf16 v[32:47], a[212:215], v[80:83], v[32:47]
    v_exp_f32 v102, v102
    ds_read_b128 v[80:83], v13 offset:1024
    s_waitcnt lgkmcnt(3)
    v_mfma_f32_32x32x16_bf16 v[16:31], a[216:219], v[84:87], v[16:31]
    v_exp_f32 v103, v103
    v_fma_f32 v100, v100, v98, v98
    v_fma_f32 v101, v101, v98, v98
    v_fma_f32 v102, v102, v98, v98
    v_fma_f32 v103, v103, v98, v98
    v_mfma_f32_32x32x16_bf16 v[32:47], a[220:223], v[84:87], v[32:47]
    v_rcp_f32 v100, v100
    ds_read_b128 v[84:87], v13 offset:2048
    s_waitcnt lgkmcnt(3)
    v_mfma_f32_32x32x16_bf16 v[16:31], a[224:227], v[88:91], v[16:31]
    v_rcp_f32 v101, v101
    v_rcp_f32 v102, v102
    v_rcp_f32 v103, v103
    v_mfma_f32_32x32x16_bf16 v[32:47], a[228:231], v[88:91], v[32:47]
    v_mul_f32 v104, v104, v100
    v_mul_f32 v105, v105, v101
    v_mul_f32 v106, v106, v102
    v_mul_f32 v107, v107, v103
    v_cvt_pk_bf16_f32 v122, v104, v105
    v_cvt_pk_bf16_f32 v123, v106, v107
    buffer_store_dwordx4 v[120:123], v1, s[4:7], s34 offen offset:1024 sc1
    s_xor_b32 s38, s16, 1
    ds_read_b128 v[88:91], v13 offset:3072
    s_waitcnt lgkmcnt(3)
    v_mfma_f32_32x32x16_bf16 v[48:63], a[0:3], v[92:95], 0
    v_mfma_f32_32x32x16_bf16 v[64:79], a[4:7], v[92:95], 0
    ds_read_b128 v[92:95], v13 offset:4096
    s_waitcnt lgkmcnt(3)
    v_mfma_f32_32x32x16_bf16 v[48:63], a[8:11], v[80:83], v[48:63]
    ds_read_b32 v96, v14 offset:0
    ds_read_b32 v97, v14 offset:128
    ds_read_b32 v98, v14 offset:256
    s_xor_b32 s20, s31, 2
    s_mul_i32 s34, s20, 114688
    s_mul_i32 s23, s12, 458752
    s_add_u32 s34, s34, s23
    s_lshl_b32 s23, s29, 13
    s_add_u32 s34, s34, s23
    s_lshl_b32 s23, s14, 11
    s_add_u32 s34, s34, s23
    s_mul_i32 s23, s15, 7340032
    s_add_u32 s34, s34, s23
    s_add_u32 s34, s34, 21397504
    v_mfma_f32_32x32x16_bf16 v[64:79], a[12:15], v[80:83], v[64:79]
    buffer_load_dwordx4 a[0:3], v1, s[4:7], s90 offen offset:2048
    ds_read_b128 v[80:83], v13 offset:5120
    s_waitcnt lgkmcnt(6)
    v_mfma_f32_32x32x16_bf16 v[48:63], a[16:19], v[84:87], v[48:63]
    v_mul_f32 v100, v16, v16
    v_mul_f32 v101, v17, v17
    v_mul_f32 v102, v18, v18
    v_mul_f32 v103, v19, v19
    v_mul_f32 v104, v16, v32
    v_mfma_f32_32x32x16_bf16 v[64:79], a[20:23], v[84:87], v[64:79]
    buffer_load_dwordx4 a[4:7], v1, s[4:7], s91 offen offset:2048
    ds_read_b128 v[84:87], v13 offset:6144
    s_waitcnt lgkmcnt(6)
    v_mfma_f32_32x32x16_bf16 v[48:63], a[24:27], v[88:91], v[48:63]
    v_mul_f32 v105, v17, v33
    v_mul_f32 v106, v18, v34
    v_mul_f32 v107, v19, v35
    s_waitcnt lgkmcnt(2)
    v_fma_f32 v100, v100, v97, v96
    v_fma_f32 v101, v101, v97, v96
    v_mfma_f32_32x32x16_bf16 v[64:79], a[28:31], v[88:91], v[64:79]
    buffer_load_dwordx4 a[8:11], v1, s[4:7], s90 offen offset:3072
    ds_read_b128 v[88:91], v13 offset:7168
    v_mfma_f32_32x32x16_bf16 v[48:63], a[32:35], v[92:95], v[48:63]
    v_fma_f32 v102, v102, v97, v96
    v_fma_f32 v103, v103, v97, v96
    v_mul_f32 v100, v100, v16
    v_mul_f32 v101, v101, v17
    v_mul_f32 v102, v102, v18
    v_mfma_f32_32x32x16_bf16 v[64:79], a[36:39], v[92:95], v[64:79]
    buffer_load_dwordx4 a[12:15], v1, s[4:7], s91 offen offset:3072
    ds_read_b128 v[92:95], v13 offset:8192
    s_waitcnt lgkmcnt(3)
    v_mfma_f32_32x32x16_bf16 v[48:63], a[40:43], v[80:83], v[48:63]
    v_mul_f32 v103, v103, v19
    v_exp_f32 v100, v100
    v_exp_f32 v101, v101
    v_mfma_f32_32x32x16_bf16 v[64:79], a[44:47], v[80:83], v[64:79]
    s_add_u32 s90, s90, 4096
    buffer_load_dwordx4 a[16:19], v1, s[4:7], s90 offen
    ds_read_b128 v[80:83], v13 offset:9216
    s_waitcnt lgkmcnt(3)
    v_mfma_f32_32x32x16_bf16 v[48:63], a[48:51], v[84:87], v[48:63]
    v_exp_f32 v102, v102
    v_exp_f32 v103, v103
    v_fma_f32 v100, v100, v98, v98
    v_fma_f32 v101, v101, v98, v98
    v_mfma_f32_32x32x16_bf16 v[64:79], a[52:55], v[84:87], v[64:79]
    s_add_u32 s91, s91, 4096
    buffer_load_dwordx4 a[20:23], v1, s[4:7], s91 offen
    ds_read_b128 v[84:87], v13 offset:10240
    s_waitcnt lgkmcnt(3)
    v_mfma_f32_32x32x16_bf16 v[48:63], a[56:59], v[88:91], v[48:63]
    v_fma_f32 v102, v102, v98, v98
    v_fma_f32 v103, v103, v98, v98
    v_rcp_f32 v100, v100
    v_rcp_f32 v101, v101
    v_mfma_f32_32x32x16_bf16 v[64:79], a[60:63], v[88:91], v[64:79]
    buffer_load_dwordx4 a[24:27], v1, s[4:7], s90 offen offset:1024
    ds_read_b128 v[88:91], v13 offset:11264
    s_waitcnt lgkmcnt(3)
    v_mfma_f32_32x32x16_bf16 v[48:63], a[64:67], v[92:95], v[48:63]
    v_rcp_f32 v102, v102
    v_rcp_f32 v103, v103
    v_mul_f32 v104, v104, v100
    v_mul_f32 v105, v105, v101
    v_mfma_f32_32x32x16_bf16 v[64:79], a[68:71], v[92:95], v[64:79]
    buffer_load_dwordx4 a[28:31], v1, s[4:7], s91 offen offset:1024
    ds_read_b128 v[92:95], v13 offset:12288
    s_waitcnt lgkmcnt(3)
    v_mfma_f32_32x32x16_bf16 v[48:63], a[72:75], v[80:83], v[48:63]
    v_mul_f32 v106, v106, v102
    v_mul_f32 v107, v107, v103
    v_cvt_pk_bf16_f32 v116, v104, v105
    v_cvt_pk_bf16_f32 v117, v106, v107
    v_mul_f32 v100, v20, v20
    v_mfma_f32_32x32x16_bf16 v[64:79], a[76:79], v[80:83], v[64:79]
    buffer_load_dwordx4 a[32:35], v1, s[4:7], s90 offen offset:2048
    ds_read_b128 v[80:83], v13 offset:13312
    s_waitcnt lgkmcnt(3)
    v_mfma_f32_32x32x16_bf16 v[48:63], a[80:83], v[84:87], v[48:63]
    v_mul_f32 v101, v21, v21
    v_mul_f32 v102, v22, v22
    v_mul_f32 v103, v23, v23
    v_mul_f32 v104, v20, v36
    v_mul_f32 v105, v21, v37
    v_mfma_f32_32x32x16_bf16 v[64:79], a[84:87], v[84:87], v[64:79]
    buffer_load_dwordx4 a[36:39], v1, s[4:7], s91 offen offset:2048
    s_waitcnt vmcnt(10)
    s_barrier
    s_add_u32 s22, s48, 6144
    s_lshl_b32 s23, s16, 11
    s_add_u32 s22, s22, s23
    v_mov_b32 v15, 1
    s_cmp_eq_u32 s14, 0
    s_cselect_b64 exec, 1, 0
    buffer_atomic_add v15, off, s[4:7], s22 sc1
    s_mov_b64 exec, -1
    ds_read_b128 v[84:87], v13 offset:14336
    s_waitcnt lgkmcnt(3)
    v_mfma_f32_32x32x16_bf16 v[48:63], a[88:91], v[88:91], v[48:63]
    v_mul_f32 v106, v22, v38
    v_mul_f32 v107, v23, v39
    v_fma_f32 v100, v100, v97, v96
    v_fma_f32 v101, v101, v97, v96
    v_fma_f32 v102, v102, v97, v96
    v_mfma_f32_32x32x16_bf16 v[64:79], a[92:95], v[88:91], v[64:79]
    buffer_load_dwordx4 a[40:43], v1, s[4:7], s90 offen offset:3072
    ds_read_b128 v[88:91], v13 offset:15360
    s_waitcnt lgkmcnt(3)
    v_mfma_f32_32x32x16_bf16 v[48:63], a[96:99], v[92:95], v[48:63]
    v_fma_f32 v103, v103, v97, v96
    v_mul_f32 v100, v100, v20
    v_mul_f32 v101, v101, v21
    v_mul_f32 v102, v102, v22
    v_mul_f32 v103, v103, v23
    v_mfma_f32_32x32x16_bf16 v[64:79], a[100:103], v[92:95], v[64:79]
    buffer_load_dwordx4 a[44:47], v1, s[4:7], s91 offen offset:3072
    ds_read_b128 v[92:95], v13 offset:16384
    s_waitcnt lgkmcnt(3)
    v_mfma_f32_32x32x16_bf16 v[48:63], a[104:107], v[80:83], v[48:63]
    v_exp_f32 v100, v100
    v_exp_f32 v101, v101
    v_exp_f32 v102, v102
    v_mfma_f32_32x32x16_bf16 v[64:79], a[108:111], v[80:83], v[64:79]
    s_add_u32 s90, s90, 4096
    buffer_load_dwordx4 a[48:51], v1, s[4:7], s90 offen
    ds_read_b128 v[80:83], v13 offset:17408
    s_waitcnt lgkmcnt(3)
    v_mfma_f32_32x32x16_bf16 v[48:63], a[112:115], v[84:87], v[48:63]
    v_exp_f32 v103, v103
    v_fma_f32 v100, v100, v98, v98
    v_fma_f32 v101, v101, v98, v98
    v_fma_f32 v102, v102, v98, v98
    v_fma_f32 v103, v103, v98, v98
    v_mfma_f32_32x32x16_bf16 v[64:79], a[116:119], v[84:87], v[64:79]
    s_add_u32 s91, s91, 4096
    buffer_load_dwordx4 a[52:55], v1, s[4:7], s91 offen
    ds_read_b128 v[84:87], v13 offset:18432
    s_waitcnt lgkmcnt(3)
    v_mfma_f32_32x32x16_bf16 v[48:63], a[120:123], v[88:91], v[48:63]
    v_rcp_f32 v100, v100
    v_rcp_f32 v101, v101
    v_rcp_f32 v102, v102
    v_mfma_f32_32x32x16_bf16 v[64:79], a[124:127], v[88:91], v[64:79]
    buffer_load_dwordx4 a[56:59], v1, s[4:7], s90 offen offset:1024
    ds_read_b128 v[88:91], v13 offset:19456
    s_waitcnt lgkmcnt(3)
    v_mfma_f32_32x32x16_bf16 v[48:63], a[128:131], v[92:95], v[48:63]
    v_rcp_f32 v103, v103
    v_mul_f32 v104, v104, v100
    v_mul_f32 v105, v105, v101
    v_mul_f32 v106, v106, v102
    v_mul_f32 v107, v107, v103
    v_mfma_f32_32x32x16_bf16 v[64:79], a[132:135], v[92:95], v[64:79]
    buffer_load_dwordx4 a[60:63], v1, s[4:7], s91 offen offset:1024
    ds_read_b128 v[92:95], v13 offset:20480
    s_waitcnt lgkmcnt(3)
    v_mfma_f32_32x32x16_bf16 v[48:63], a[136:139], v[80:83], v[48:63]
    v_cvt_pk_bf16_f32 v118, v104, v105
    v_cvt_pk_bf16_f32 v119, v106, v107
    buffer_store_dwordx4 v[116:119], v1, s[4:7], s34 offen sc1
    v_mul_f32 v100, v24, v24
    v_mul_f32 v101, v25, v25
    v_mfma_f32_32x32x16_bf16 v[64:79], a[140:143], v[80:83], v[64:79]
    buffer_load_dwordx4 a[64:67], v1, s[4:7], s90 offen offset:2048
    ds_read_b128 v[80:83], v13 offset:21504
    s_waitcnt lgkmcnt(3)
    v_mfma_f32_32x32x16_bf16 v[48:63], a[144:147], v[84:87], v[48:63]
    v_mul_f32 v102, v26, v26
    v_mul_f32 v103, v27, v27
    v_mul_f32 v104, v24, v40
    v_mul_f32 v105, v25, v41
    v_mul_f32 v106, v26, v42
    v_mfma_f32_32x32x16_bf16 v[64:79], a[148:151], v[84:87], v[64:79]
    buffer_load_dwordx4 a[68:71], v1, s[4:7], s91 offen offset:2048
    ds_read_b128 v[84:87], v13 offset:22528
    s_waitcnt lgkmcnt(3)
    v_mfma_f32_32x32x16_bf16 v[48:63], a[152:155], v[88:91], v[48:63]
    v_mul_f32 v107, v27, v43
    v_fma_f32 v100, v100, v97, v96
    v_fma_f32 v101, v101, v97, v96
    v_fma_f32 v102, v102, v97, v96
    v_fma_f32 v103, v103, v97, v96
    v_mfma_f32_32x32x16_bf16 v[64:79], a[156:159], v[88:91], v[64:79]
    buffer_load_dwordx4 a[72:75], v1, s[4:7], s90 offen offset:3072
    ds_read_b128 v[88:91], v13 offset:23552
    s_waitcnt lgkmcnt(3)
    v_mfma_f32_32x32x16_bf16 v[48:63], a[160:163], v[92:95], v[48:63]
    v_mul_f32 v100, v100, v24
    v_mul_f32 v101, v101, v25
    v_mul_f32 v102, v102, v26
    v_mul_f32 v103, v103, v27
    v_exp_f32 v100, v100
    v_mfma_f32_32x32x16_bf16 v[64:79], a[164:167], v[92:95], v[64:79]
    buffer_load_dwordx4 a[76:79], v1, s[4:7], s91 offen offset:3072
    ds_read_b128 v[92:95], v13 offset:24576
    s_waitcnt lgkmcnt(3)
    v_mfma_f32_32x32x16_bf16 v[48:63], a[168:171], v[80:83], v[48:63]
    v_exp_f32 v101, v101
    v_exp_f32 v102, v102
    v_exp_f32 v103, v103
    v_mfma_f32_32x32x16_bf16 v[64:79], a[172:175], v[80:83], v[64:79]
    s_add_u32 s90, s90, 4096
    buffer_load_dwordx4 a[80:83], v1, s[4:7], s90 offen
    ds_read_b128 v[80:83], v13 offset:25600
    s_waitcnt lgkmcnt(3)
    v_mfma_f32_32x32x16_bf16 v[48:63], a[176:179], v[84:87], v[48:63]
    v_fma_f32 v100, v100, v98, v98
    v_fma_f32 v101, v101, v98, v98
    v_fma_f32 v102, v102, v98, v98
    v_fma_f32 v103, v103, v98, v98
    v_rcp_f32 v100, v100
    v_mfma_f32_32x32x16_bf16 v[64:79], a[180:183], v[84:87], v[64:79]
    s_add_u32 s91, s91, 4096
    buffer_load_dwordx4 a[84:87], v1, s[4:7], s91 offen
    s_lshl_b32 s39, s38, 11
    s_add_u32 s39, s39, s48
    s_add_u32 s39, s39, 6144
    s_mov_b64 exec, 256
    buffer_load_dword v0, off, s[4:7], s39 sc1
    s_mov_b64 exec, -1
    ds_read_b128 v[84:87], v13 offset:26624
    s_waitcnt lgkmcnt(3)
    v_mfma_f32_32x32x16_bf16 v[48:63], a[184:187], v[88:91], v[48:63]
    v_rcp_f32 v101, v101
    v_rcp_f32 v102, v102
    v_rcp_f32 v103, v103
    v_mfma_f32_32x32x16_bf16 v[64:79], a[188:191], v[88:91], v[64:79]
    buffer_load_dwordx4 a[88:91], v1, s[4:7], s90 offen offset:1024
    ds_read_b128 v[88:91], v13 offset:27648
    s_waitcnt lgkmcnt(3)
    v_mfma_f32_32x32x16_bf16 v[48:63], a[192:195], v[92:95], v[48:63]
    v_mul_f32 v104, v104, v100
    v_mul_f32 v105, v105, v101
    v_mul_f32 v106, v106, v102
    v_mul_f32 v107, v107, v103
    v_cvt_pk_bf16_f32 v120, v104, v105
    v_mfma_f32_32x32x16_bf16 v[64:79], a[196:199], v[92:95], v[64:79]
    buffer_load_dwordx4 a[92:95], v1, s[4:7], s91 offen offset:1024
    ds_read_b128 v[92:95], v109 offset:1024
    s_waitcnt lgkmcnt(3)
    v_mfma_f32_32x32x16_bf16 v[48:63], a[200:203], v[80:83], v[48:63]
    v_cvt_pk_bf16_f32 v121, v106, v107
    v_mul_f32 v100, v28, v28
    v_mul_f32 v101, v29, v29
    v_mul_f32 v102, v30, v30
    v_mul_f32 v103, v31, v31
    v_mfma_f32_32x32x16_bf16 v[64:79], a[204:207], v[80:83], v[64:79]
    v_mul_f32 v104, v28, v44
    v_mul_f32 v105, v29, v45
    s_waitcnt lgkmcnt(2)
    v_mfma_f32_32x32x16_bf16 v[48:63], a[208:211], v[84:87], v[48:63]
    v_mul_f32 v106, v30, v46
    v_mul_f32 v107, v31, v47
    v_fma_f32 v100, v100, v97, v96
    v_fma_f32 v101, v101, v97, v96
    v_fma_f32 v102, v102, v97, v96
    v_mfma_f32_32x32x16_bf16 v[64:79], a[212:215], v[84:87], v[64:79]
    v_fma_f32 v103, v103, v97, v96
    v_mul_f32 v100, v100, v28
    s_waitcnt lgkmcnt(1)
    v_mfma_f32_32x32x16_bf16 v[48:63], a[216:219], v[88:91], v[48:63]
    v_mul_f32 v101, v101, v29
    v_mul_f32 v102, v102, v30
    v_mul_f32 v103, v103, v31
    v_exp_f32 v100, v100
    v_mfma_f32_32x32x16_bf16 v[64:79], a[220:223], v[88:91], v[64:79]
    v_exp_f32 v101, v101
    s_waitcnt lgkmcnt(0)
    v_mfma_f32_32x32x16_bf16 v[48:63], a[224:227], v[92:95], v[48:63]
    v_exp_f32 v102, v102
    v_exp_f32 v103, v103
    v_fma_f32 v100, v100, v98, v98
    v_fma_f32 v101, v101, v98, v98
    v_mfma_f32_32x32x16_bf16 v[64:79], a[228:231], v[92:95], v[64:79]
    v_fma_f32 v102, v102, v98, v98
    v_fma_f32 v103, v103, v98, v98
    v_rcp_f32 v100, v100
    v_rcp_f32 v101, v101
    v_rcp_f32 v102, v102
    v_rcp_f32 v103, v103
    v_mul_f32 v104, v104, v100
    v_mul_f32 v105, v105, v101
    v_mul_f32 v106, v106, v102
    v_mul_f32 v107, v107, v103
    v_cvt_pk_bf16_f32 v122, v104, v105
    v_cvt_pk_bf16_f32 v123, v106, v107
    buffer_store_dwordx4 v[120:123], v1, s[4:7], s34 offen offset:1024 sc1
    s_mul_i32 s53, s16, 56
    s_sub_u32 s53, 56, s53
    s_mul_i32 s54, s14, 14
    s_add_u32 s53, s53, s54
    s_andn2_b32 s44, s50, 1
    s_add_u32 s44, s44, 0
    s_mul_i32 s44, s44, 112
    s_add_u32 s44, s44, s53
    s_lshl_b32 s44, s44, 10
    s_mul_i32 s53, s15, 7340032
    s_add_u32 s44, s44, s53
    s_add_u32 s44, s44, 21397504
    s_mul_i32 s53, s16, 56
    s_sub_u32 s53, 56, s53
    s_mul_i32 s54, s14, 14
    s_add_u32 s53, s53, s54
    s_andn2_b32 s45, s50, 1
    s_add_u32 s45, s45, 1
    s_mul_i32 s45, s45, 112
    s_add_u32 s45, s45, s53
    s_lshl_b32 s45, s45, 10
    s_mul_i32 s53, s15, 7340032
    s_add_u32 s45, s45, s53
    s_add_u32 s45, s45, 21397504
    s_mul_i32 s53, s16, 56
    s_mul_i32 s54, s14, 14
    s_add_u32 s53, s53, s54
    s_andn2_b32 s46, s50, 1
    s_add_u32 s46, s46, 0
    s_mul_i32 s46, s46, 112
    s_add_u32 s46, s46, s53
    s_lshl_b32 s46, s46, 10
    s_mul_i32 s53, s15, 7340032
    s_add_u32 s46, s46, s53
    s_add_u32 s46, s46, 21397504
    s_mul_i32 s53, s16, 56
    s_mul_i32 s54, s14, 14
    s_add_u32 s53, s53, s54
    s_andn2_b32 s47, s50, 1
    s_add_u32 s47, s47, 1
    s_mul_i32 s47, s47, 112
    s_add_u32 s47, s47, s53
    s_lshl_b32 s47, s47, 10
    s_mul_i32 s53, s15, 7340032
    s_add_u32 s47, s47, s53
    s_add_u32 s47, s47, 21397504
    s_waitcnt vmcnt(3)
    v_readlane_b32 s23, v0, 8
    s_nop 0
    s_cmp_ge_u32 s23, 7
    s_nop 2
    s_cbranch_scc1 apk_13
    s_mov_b32 s28, 0
    s_mov_b64 exec, 256
    s_nop 0
apl_14:
    buffer_load_dword v0, off, s[4:7], s39 sc1
    s_add_u32 s28, s28, 1
    s_cmp_gt_u32 s28, 1000000
    s_cbranch_scc1 apl_14_x
    s_waitcnt vmcnt(0)
    v_readlane_b32 s23, v0, 8
    s_nop 0
    s_cmp_lt_u32 s23, 7
    s_nop 2
    s_cbranch_scc1 apl_14
apl_14_x:
    s_waitcnt vmcnt(0)
    s_mov_b64 exec, -1
    s_nop 0
apk_13:
    ds_read_b32 v96, v14 offset:384
    ds_read_b32 v97, v14 offset:512
    ds_read_b32 v98, v14 offset:640
    s_xor_b32 s20, s31, 3
    buffer_load_dwordx4 a[96:99], v1, s[4:7], s44 offen sc1
    s_mul_i32 s34, s20, 114688
    s_mul_i32 s23, s12, 458752
    s_add_u32 s34, s34, s23
    s_lshl_b32 s23, s29, 13
    s_add_u32 s34, s34, s23
    s_lshl_b32 s23, s14, 11
    s_add_u32 s34, s34, s23
    s_mul_i32 s23, s15, 7340032
    buffer_load_dwordx4 a[100:103], v1, s[4:7], s45 offen sc1
    s_add_u32 s34, s34, s23
    s_add_u32 s34, s34, 21397504
    v_pk_mul_f32 v[100:101], v[48:49], v[48:49]
    v_pk_mul_f32 v[102:103], v[50:51], v[50:51]
    v_pk_mul_f32 v[104:105], v[48:49], v[64:65]
    v_pk_mul_f32 v[106:107], v[50:51], v[66:67]
    s_waitcnt lgkmcnt(0)
    v_pk_fma_f32 v[100:101], v[100:101], v[96:97], v[96:97] op_sel:[0,1,0] op_sel_hi:[1,1,0] neg_lo:[0,0,0] neg_hi:[0,0,0]
    buffer_load_dwordx4 a[104:107], v1, s[4:7], s44 offen offset:1024 sc1
    v_pk_fma_f32 v[102:103], v[102:103], v[96:97], v[96:97] op_sel:[0,1,0] op_sel_hi:[1,1,0] neg_lo:[0,0,0] neg_hi:[0,0,0]
    v_pk_mul_f32 v[100:101], v[100:101], v[48:49]
    v_pk_mul_f32 v[102:103], v[102:103], v[50:51]
    v_exp_f32 v100, v100
    v_exp_f32 v101, v101
    v_exp_f32 v102, v102
    v_exp_f32 v103, v103
    v_pk_fma_f32 v[100:101], v[100:101], v[98:99], v[98:99] op_sel:[0,0,0] op_sel_hi:[1,0,0] neg_lo:[0,0,0] neg_hi:[0,0,0]
    buffer_load_dwordx4 a[108:111], v1, s[4:7], s45 offen offset:1024 sc1
    v_pk_fma_f32 v[102:103], v[102:103], v[98:99], v[98:99] op_sel:[0,0,0] op_sel_hi:[1,0,0] neg_lo:[0,0,0] neg_hi:[0,0,0]
    v_rcp_f32 v100, v100
    s_waitcnt vmcnt(4)
    s_barrier
    s_add_u32 s22, s48, 16384
    s_lshl_b32 s23, s16, 11
    s_add_u32 s22, s22, s23
    v_mov_b32 v15, 1
    s_cmp_eq_u32 s14, 0
    s_cselect_b64 exec, 1, 0
    buffer_atomic_add v15, off, s[4:7], s22 sc1
    s_mov_b64 exec, -1
    buffer_load_dwordx4 a[112:115], v1, s[4:7], s44 offen offset:2048 sc1
    v_rcp_f32 v101, v101
    v_rcp_f32 v102, v102
    v_rcp_f32 v103, v103
    v_pk_mul_f32 v[104:105], v[104:105], v[100:101]
    v_pk_mul_f32 v[106:107], v[106:107], v[102:103]
    v_cvt_pk_bf16_f32 v116, v104, v105
    v_cvt_pk_bf16_f32 v117, v106, v107
    v_pk_mul_f32 v[100:101], v[52:53], v[52:53]
    buffer_load_dwordx4 a[116:119], v1, s[4:7], s45 offen offset:2048 sc1
    v_pk_mul_f32 v[102:103], v[54:55], v[54:55]
    v_pk_mul_f32 v[104:105], v[52:53], v[68:69]
    v_pk_mul_f32 v[106:107], v[54:55], v[70:71]
    v_pk_fma_f32 v[100:101], v[100:101], v[96:97], v[96:97] op_sel:[0,1,0] op_sel_hi:[1,1,0] neg_lo:[0,0,0] neg_hi:[0,0,0]
    v_pk_fma_f32 v[102:103], v[102:103], v[96:97], v[96:97] op_sel:[0,1,0] op_sel_hi:[1,1,0] neg_lo:[0,0,0] neg_hi:[0,0,0]
    v_pk_mul_f32 v[100:101], v[100:101], v[52:53]
    v_pk_mul_f32 v[102:103], v[102:103], v[54:55]
    v_exp_f32 v100, v100
    buffer_load_dwordx4 a[120:123], v1, s[4:7], s44 offen offset:3072 sc1
    v_exp_f32 v101, v101
    v_exp_f32 v102, v102
    v_exp_f32 v103, v103
    v_pk_fma_f32 v[100:101], v[100:101], v[98:99], v[98:99] op_sel:[0,0,0] op_sel_hi:[1,0,0] neg_lo:[0,0,0] neg_hi:[0,0,0]
    v_pk_fma_f32 v[102:103], v[102:103], v[98:99], v[98:99] op_sel:[0,0,0] op_sel_hi:[1,0,0] neg_lo:[0,0,0] neg_hi:[0,0,0]
    v_rcp_f32 v100, v100
    v_rcp_f32 v101, v101
    v_rcp_f32 v102, v102
    buffer_load_dwordx4 a[124:127], v1, s[4:7], s45 offen offset:3072 sc1
    v_rcp_f32 v103, v103
    v_pk_mul_f32 v[104:105], v[104:105], v[100:101]
    v_pk_mul_f32 v[106:107], v[106:107], v[102:103]
    v_cvt_pk_bf16_f32 v118, v104, v105
    v_cvt_pk_bf16_f32 v119, v106, v107
    buffer_store_dwordx4 v[116:119], v1, s[4:7], s34 offen sc1
    v_pk_mul_f32 v[100:101], v[56:57], v[56:57]
    v_pk_mul_f32 v[102:103], v[58:59], v[58:59]
    s_add_u32 s44, s44, 4096
    buffer_load_dwordx4 a[128:131], v1, s[4:7], s44 offen sc1
    v_pk_mul_f32 v[104:105], v[56:57], v[72:73]
    v_pk_mul_f32 v[106:107], v[58:59], v[74:75]
    v_pk_fma_f32 v[100:101], v[100:101], v[96:97], v[96:97] op_sel:[0,1,0] op_sel_hi:[1,1,0] neg_lo:[0,0,0] neg_hi:[0,0,0]
    v_pk_fma_f32 v[102:103], v[102:103], v[96:97], v[96:97] op_sel:[0,1,0] op_sel_hi:[1,1,0] neg_lo:[0,0,0] neg_hi:[0,0,0]
    v_pk_mul_f32 v[100:101], v[100:101], v[56:57]
    v_pk_mul_f32 v[102:103], v[102:103], v[58:59]
    v_exp_f32 v100, v100
    v_exp_f32 v101, v101
    s_add_u32 s45, s45, 4096
    buffer_load_dwordx4 a[132:135], v1, s[4:7], s45 offen sc1
    v_exp_f32 v102, v102
    v_exp_f32 v103, v103
    v_pk_fma_f32 v[100:101], v[100:101], v[98:99], v[98:99] op_sel:[0,0,0] op_sel_hi:[1,0,0] neg_lo:[0,0,0] neg_hi:[0,0,0]
    v_pk_fma_f32 v[102:103], v[102:103], v[98:99], v[98:99] op_sel:[0,0,0] op_sel_hi:[1,0,0] neg_lo:[0,0,0] neg_hi:[0,0,0]
    v_rcp_f32 v100, v100
    v_rcp_f32 v101, v101
    v_rcp_f32 v102, v102
    v_rcp_f32 v103, v103
    buffer_load_dwordx4 a[136:139], v1, s[4:7], s44 offen offset:1024 sc1
    v_pk_mul_f32 v[104:105], v[104:105], v[100:101]
    v_pk_mul_f32 v[106:107], v[106:107], v[102:103]
    v_cvt_pk_bf16_f32 v120, v104, v105
    v_cvt_pk_bf16_f32 v121, v106, v107
    v_pk_mul_f32 v[100:101], v[60:61], v[60:61]
    v_pk_mul_f32 v[102:103], v[62:63], v[62:63]
    v_pk_mul_f32 v[104:105], v[60:61], v[76:77]
    v_pk_mul_f32 v[106:107], v[62:63], v[78:79]
    buffer_load_dwordx4 a[140:143], v1, s[4:7], s45 offen offset:1024 sc1
    v_pk_fma_f32 v[100:101], v[100:101], v[96:97], v[96:97] op_sel:[0,1,0] op_sel_hi:[1,1,0] neg_lo:[0,0,0] neg_hi:[0,0,0]
    v_pk_fma_f32 v[102:103], v[102:103], v[96:97], v[96:97] op_sel:[0,1,0] op_sel_hi:[1,1,0] neg_lo:[0,0,0] neg_hi:[0,0,0]
    v_pk_mul_f32 v[100:101], v[100:101], v[60:61]
    v_pk_mul_f32 v[102:103], v[102:103], v[62:63]
    v_exp_f32 v100, v100
    v_exp_f32 v101, v101
    v_exp_f32 v102, v102
    v_exp_f32 v103, v103
    v_pk_fma_f32 v[100:101], v[100:101], v[98:99], v[98:99] op_sel:[0,0,0] op_sel_hi:[1,0,0] neg_lo:[0,0,0] neg_hi:[0,0,0]
    v_pk_fma_f32 v[102:103], v[102:103], v[98:99], v[98:99] op_sel:[0,0,0] op_sel_hi:[1,0,0] neg_lo:[0,0,0] neg_hi:[0,0,0]
    v_rcp_f32 v100, v100
    v_rcp_f32 v101, v101
    v_rcp_f32 v102, v102
    v_rcp_f32 v103, v103
    v_pk_mul_f32 v[104:105], v[104:105], v[100:101]
    v_pk_mul_f32 v[106:107], v[106:107], v[102:103]
    v_cvt_pk_bf16_f32 v122, v104, v105
    v_cvt_pk_bf16_f32 v123, v106, v107
    buffer_store_dwordx4 v[120:123], v1, s[4:7], s34 offen offset:1024 sc1
    s_xor_b32 s20, s14, 1
    s_mul_i32 s20, s20, 12288
    s_add_u32 s20, s20, 89088
    v_add_u32 v9, s20, v1
    s_xor_b32 s20, s14, 2
    s_mul_i32 s20, s20, 12288
    s_add_u32 s20, s20, 93184
    v_add_u32 v10, s20, v1
    s_xor_b32 s20, s14, 3
    s_mul_i32 s20, s20, 12288
    s_add_u32 s20, s20, 97280
    v_add_u32 v11, s20, v1
    s_mul_i32 s20, s14, 12288
    s_add_u32 s20, s20, 89088
    v_add_u32 v8, s20, v1
    s_waitcnt vmcnt(13)
    v_mfma_f32_32x32x16_bf16 v[16:31], v[128:131], a[96:99], 0
    v_mfma_f32_32x32x16_bf16 v[32:47], v[132:135], a[96:99], 0
    buffer_load_dwordx4 a[144:147], v1, s[4:7], s44 offen offset:2048 sc1
    s_waitcnt vmcnt(13)
    v_mfma_f32_32x32x16_bf16 v[48:63], v[128:131], a[100:103], 0
    v_mfma_f32_32x32x16_bf16 v[64:79], v[132:135], a[100:103], 0
    buffer_load_dwordx4 a[148:151], v1, s[4:7], s45 offen offset:2048 sc1
    s_waitcnt vmcnt(13)
    v_mfma_f32_32x32x16_bf16 v[16:31], v[136:139], a[104:107], v[16:31]
    v_mfma_f32_32x32x16_bf16 v[32:47], v[140:143], a[104:107], v[32:47]
    buffer_load_dwordx4 a[152:155], v1, s[4:7], s44 offen offset:3072 sc1
    s_waitcnt vmcnt(13)
    v_mfma_f32_32x32x16_bf16 v[48:63], v[136:139], a[108:111], v[48:63]
    v_mfma_f32_32x32x16_bf16 v[64:79], v[140:143], a[108:111], v[64:79]
    buffer_load_dwordx4 a[156:159], v1, s[4:7], s45 offen offset:3072 sc1
    s_waitcnt vmcnt(13)
    v_mfma_f32_32x32x16_bf16 v[16:31], v[144:147], a[112:115], v[16:31]
    v_mfma_f32_32x32x16_bf16 v[32:47], v[148:151], a[112:115], v[32:47]
    s_add_u32 s44, s44, 4096
    buffer_load_dwordx4 a[160:163], v1, s[4:7], s44 offen sc1
    s_waitcnt vmcnt(13)
    v_mfma_f32_32x32x16_bf16 v[48:63], v[144:147], a[116:119], v[48:63]
    v_mfma_f32_32x32x16_bf16 v[64:79], v[148:151], a[116:119], v[64:79]
    s_add_u32 s45, s45, 4096
    buffer_load_dwordx4 a[164:167], v1, s[4:7], s45 offen sc1
    s_lshl_b32 s39, s16, 11
    s_add_u32 s39, s39, s48
    s_add_u32 s39, s39, 16384
    s_mov_b64 exec, 512
    buffer_load_dword v0, off, s[4:7], s39 sc1
    s_mov_b64 exec, -1
    s_waitcnt vmcnt(14)
    v_mfma_f32_32x32x16_bf16 v[16:31], v[152:155], a[120:123], v[16:31]
    v_mfma_f32_32x32x16_bf16 v[32:47], v[156:159], a[120:123], v[32:47]
    buffer_load_dwordx4 a[168:171], v1, s[4:7], s44 offen offset:1024 sc1
    s_waitcnt vmcnt(14)
    v_mfma_f32_32x32x16_bf16 v[48:63], v[152:155], a[124:127], v[48:63]
    v_mfma_f32_32x32x16_bf16 v[64:79], v[156:159], a[124:127], v[64:79]
    buffer_load_dwordx4 a[172:175], v1, s[4:7], s45 offen offset:1024 sc1
    s_waitcnt vmcnt(9)
    s_barrier
    s_add_u32 s22, s48, 10240
    s_lshl_b32 s23, s16, 11
    s_add_u32 s22, s22, s23
    v_mov_b32 v15, 1
    s_cmp_eq_u32 s14, 0
    s_cselect_b64 exec, 1, 0
    buffer_atomic_add v15, off, s[4:7], s22 sc1
    s_mov_b64 exec, -1
    v_mfma_f32_32x32x16_bf16 v[16:31], v[160:163], a[128:131], v[16:31]
    v_mfma_f32_32x32x16_bf16 v[32:47], v[164:167], a[128:131], v[32:47]
    buffer_load_dwordx4 a[176:179], v1, s[4:7], s44 offen offset:2048 sc1
    v_mfma_f32_32x32x16_bf16 v[48:63], v[160:163], a[132:135], v[48:63]
    v_mfma_f32_32x32x16_bf16 v[64:79], v[164:167], a[132:135], v[64:79]
    buffer_load_dwordx4 a[180:183], v1, s[4:7], s45 offen offset:2048 sc1
    v_mfma_f32_32x32x16_bf16 v[16:31], v[168:171], a[136:139], v[16:31]
    v_mfma_f32_32x32x16_bf16 v[32:47], v[172:175], a[136:139], v[32:47]
    buffer_load_dwordx4 a[184:187], v1, s[4:7], s44 offen offset:3072 sc1
    v_mfma_f32_32x32x16_bf16 v[48:63], v[168:171], a[140:143], v[48:63]
    v_mfma_f32_32x32x16_bf16 v[64:79], v[172:175], a[140:143], v[64:79]
    buffer_load_dwordx4 a[188:191], v1, s[4:7], s45 offen offset:3072 sc1
    s_waitcnt vmcnt(12)
    v_mfma_f32_32x32x16_bf16 v[16:31], v[176:179], a[144:147], v[16:31]
    v_mfma_f32_32x32x16_bf16 v[32:47], v[180:183], a[144:147], v[32:47]
    s_add_u32 s44, s44, 4096
    buffer_load_dwordx4 a[192:195], v1, s[4:7], s44 offen sc1
    s_waitcnt vmcnt(12)
    v_mfma_f32_32x32x16_bf16 v[48:63], v[176:179], a[148:151], v[48:63]
    v_mfma_f32_32x32x16_bf16 v[64:79], v[180:183], a[148:151], v[64:79]
    s_add_u32 s45, s45, 4096
    buffer_load_dwordx4 a[196:199], v1, s[4:7], s45 offen sc1
    s_waitcnt vmcnt(12)
    v_mfma_f32_32x32x16_bf16 v[16:31], v[184:187], a[152:155], v[16:31]
    v_mfma_f32_32x32x16_bf16 v[32:47], v[188:191], a[152:155], v[32:47]
    buffer_load_dwordx4 a[200:203], v1, s[4:7], s44 offen offset:1024 sc1
    s_waitcnt vmcnt(12)
    v_mfma_f32_32x32x16_bf16 v[48:63], v[184:187], a[156:159], v[48:63]
    v_mfma_f32_32x32x16_bf16 v[64:79], v[188:191], a[156:159], v[64:79]
    buffer_load_dwordx4 a[204:207], v1, s[4:7], s45 offen offset:1024 sc1
    s_waitcnt vmcnt(12)
    v_mfma_f32_32x32x16_bf16 v[16:31], v[192:195], a[160:163], v[16:31]
    v_mfma_f32_32x32x16_bf16 v[32:47], v[196:199], a[160:163], v[32:47]
    s_waitcnt vmcnt(10)
    v_readlane_b32 s23, v0, 9
    s_nop 0
    s_cmp_ge_u32 s23, 7
    s_nop 7
    s_cbranch_scc1 apk_15
    s_mov_b32 s28, 0
    s_mov_b64 exec, 512
    s_nop 0
apl_16:
    buffer_load_dword v0, off, s[4:7], s39 sc1
    s_add_u32 s28, s28, 1
    s_cmp_gt_u32 s28, 1000000
    s_cbranch_scc1 apl_16_x
    s_waitcnt vmcnt(0)
    v_readlane_b32 s23, v0, 9
    s_nop 0
    s_cmp_lt_u32 s23, 7
    s_nop 2
    s_cbranch_scc1 apl_16
apl_16_x:
    s_waitcnt vmcnt(0)
    s_mov_b64 exec, -1
    s_nop 0
apk_15:
    buffer_load_dwordx4 a[208:211], v1, s[4:7], s46 offen sc1
    v_mfma_f32_32x32x16_bf16 v[48:63], v[192:195], a[164:167], v[48:63]
    v_mfma_f32_32x32x16_bf16 v[64:79], v[196:199], a[164:167], v[64:79]
    buffer_load_dwordx4 a[212:215], v1, s[4:7], s46 offen offset:1024 sc1
    s_waitcnt vmcnt(11)
    v_mfma_f32_32x32x16_bf16 v[16:31], v[200:203], a[168:171], v[16:31]
    v_mfma_f32_32x32x16_bf16 v[32:47], v[204:207], a[168:171], v[32:47]
    buffer_load_dwordx4 a[216:219], v1, s[4:7], s46 offen offset:2048 sc1
    s_waitcnt vmcnt(11)
    v_mfma_f32_32x32x16_bf16 v[48:63], v[200:203], a[172:175], v[48:63]
    v_mfma_f32_32x32x16_bf16 v[64:79], v[204:207], a[172:175], v[64:79]
    buffer_load_dwordx4 a[220:223], v1, s[4:7], s46 offen offset:3072 sc1
    s_lshl_b32 s39, s16, 11
    s_add_u32 s39, s39, s48
    s_add_u32 s39, s39, 10240
    s_mov_b64 exec, 1024
    buffer_load_dword v0, off, s[4:7], s39 sc1
    s_mov_b64 exec, -1
    s_waitcnt vmcnt(12)
    v_mfma_f32_32x32x16_bf16 v[16:31], v[208:211], a[176:179], v[16:31]
    v_mfma_f32_32x32x16_bf16 v[32:47], v[212:215], a[176:179], v[32:47]
    s_add_u32 s46, s46, 4096
    buffer_load_dwordx4 a[96:99], v1, s[4:7], s46 offen sc1
    s_waitcnt vmcnt(12)
    v_mfma_f32_32x32x16_bf16 v[48:63], v[208:211], a[180:183], v[48:63]
    v_mfma_f32_32x32x16_bf16 v[64:79], v[212:215], a[180:183], v[64:79]
    buffer_load_dwordx4 a[100:103], v1, s[4:7], s46 offen offset:1024 sc1
    s_waitcnt vmcnt(12)
    v_mfma_f32_32x32x16_bf16 v[16:31], v[216:219], a[184:187], v[16:31]
    v_mfma_f32_32x32x16_bf16 v[32:47], v[220:223], a[184:187], v[32:47]
    buffer_load_dwordx4 a[104:107], v1, s[4:7], s46 offen offset:2048 sc1
    s_waitcnt vmcnt(12)
    v_mfma_f32_32x32x16_bf16 v[48:63], v[216:219], a[188:191], v[48:63]
    v_mfma_f32_32x32x16_bf16 v[64:79], v[220:223], a[188:191], v[64:79]
    buffer_load_dwordx4 a[108:111], v1, s[4:7], s46 offen offset:3072 sc1
    s_waitcnt vmcnt(12)
    v_mfma_f32_32x32x16_bf16 v[16:31], v[224:227], a[192:195], v[16:31]
    v_mfma_f32_32x32x16_bf16 v[32:47], v[228:231], a[192:195], v[32:47]
    s_add_u32 s46, s46, 4096
    buffer_load_dwordx4 a[112:115], v1, s[4:7], s46 offen sc1
    s_waitcnt vmcnt(12)
    v_mfma_f32_32x32x16_bf16 v[48:63], v[224:227], a[196:199], v[48:63]
    v_mfma_f32_32x32x16_bf16 v[64:79], v[228:231], a[196:199], v[64:79]
    buffer_load_dwordx4 a[116:119], v1, s[4:7], s46 offen offset:1024 sc1
    s_waitcnt vmcnt(12)
    v_mfma_f32_32x32x16_bf16 v[16:31], v[232:235], a[200:203], v[16:31]
    v_mfma_f32_32x32x16_bf16 v[32:47], v[236:239], a[200:203], v[32:47]
    buffer_load_dwordx4 a[120:123], v1, s[4:7], s46 offen offset:2048 sc1
    s_waitcnt vmcnt(12)
    v_mfma_f32_32x32x16_bf16 v[48:63], v[232:235], a[204:207], v[48:63]
    v_mfma_f32_32x32x16_bf16 v[64:79], v[236:239], a[204:207], v[64:79]
    buffer_load_dwordx4 a[124:127], v1, s[4:7], s46 offen offset:3072 sc1
    s_waitcnt vmcnt(12)
    v_mfma_f32_32x32x16_bf16 v[16:31], v[240:243], a[208:211], v[16:31]
    v_mfma_f32_32x32x16_bf16 v[32:47], v[244:247], a[208:211], v[32:47]
    s_add_u32 s46, s46, 4096
    buffer_load_dwordx4 a[128:131], v1, s[4:7], s46 offen sc1
    s_waitcnt vmcnt(12)
    v_mfma_f32_32x32x16_bf16 v[16:31], v[248:251], a[212:215], v[16:31]
    v_mfma_f32_32x32x16_bf16 v[32:47], v[252:255], a[212:215], v[32:47]
    buffer_load_dwordx4 a[132:135], v1, s[4:7], s46 offen offset:1024 sc1
    s_waitcnt vmcnt(12)
    v_mfma_f32_32x32x16_bf16 v[16:31], a[0:3], a[216:219], v[16:31]
    v_mfma_f32_32x32x16_bf16 v[32:47], a[4:7], a[216:219], v[32:47]
    s_waitcnt vmcnt(10)
    v_readlane_b32 s23, v0, 10
    s_nop 0
    s_cmp_ge_u32 s23, 7
    s_nop 7
    s_cbranch_scc1 apk_17
    s_mov_b32 s28, 0
    s_mov_b64 exec, 1024
    s_nop 0
apl_18:
    buffer_load_dword v0, off, s[4:7], s39 sc1
    s_add_u32 s28, s28, 1
    s_cmp_gt_u32 s28, 1000000
    s_cbranch_scc1 apl_18_x
    s_waitcnt vmcnt(0)
    v_readlane_b32 s23, v0, 10
    s_nop 0
    s_cmp_lt_u32 s23, 7
    s_nop 2
    s_cbranch_scc1 apl_18
apl_18_x:
    s_waitcnt vmcnt(0)
    s_mov_b64 exec, -1
    s_nop 0
apk_17:
    buffer_load_dwordx4 a[136:139], v1, s[4:7], s47 offen sc1
    v_mfma_f32_32x32x16_bf16 v[16:31], a[8:11], a[220:223], v[16:31]
    v_mfma_f32_32x32x16_bf16 v[32:47], a[12:15], a[220:223], v[32:47]
    buffer_load_dwordx4 a[140:143], v1, s[4:7], s47 offen offset:1024 sc1
    s_waitcnt vmcnt(11)
    v_mfma_f32_32x32x16_bf16 v[16:31], a[16:19], a[96:99], v[16:31]
    v_mfma_f32_32x32x16_bf16 v[32:47], a[20:23], a[96:99], v[32:47]
    buffer_load_dwordx4 a[144:147], v1, s[4:7], s47 offen offset:2048 sc1
    s_waitcnt vmcnt(11)
    v_mfma_f32_32x32x16_bf16 v[16:31], a[24:27], a[100:103], v[16:31]
    v_mfma_f32_32x32x16_bf16 v[32:47], a[28:31], a[100:103], v[32:47]
    buffer_load_dwordx4 a[148:151], v1, s[4:7], s47 offen offset:3072 sc1
    s_waitcnt vmcnt(11)
    v_mfma_f32_32x32x16_bf16 v[16:31], a[32:35], a[104:107], v[16:31]
    v_mfma_f32_32x32x16_bf16 v[32:47], a[36:39], a[104:107], v[32:47]
    s_add_u32 s47, s47, 4096
    buffer_load_dwordx4 a[152:155], v1, s[4:7], s47 offen sc1
    s_waitcnt vmcnt(11)
    v_mfma_f32_32x32x16_bf16 v[16:31], a[40:43], a[108:111], v[16:31]
    v_mfma_f32_32x32x16_bf16 v[32:47], a[44:47], a[108:111], v[32:47]
    buffer_load_dwordx4 a[156:159], v1, s[4:7], s47 offen offset:1024 sc1
    s_waitcnt vmcnt(11)
    v_mfma_f32_32x32x16_bf16 v[16:31], a[48:51], a[112:115], v[16:31]
    v_mfma_f32_32x32x16_bf16 v[32:47], a[52:55], a[112:115], v[32:47]
    buffer_load_dwordx4 a[160:163], v1, s[4:7], s47 offen offset:2048 sc1
    s_waitcnt vmcnt(11)
    v_mfma_f32_32x32x16_bf16 v[16:31], a[56:59], a[116:119], v[16:31]
    v_mfma_f32_32x32x16_bf16 v[32:47], a[60:63], a[116:119], v[32:47]
    buffer_load_dwordx4 a[164:167], v1, s[4:7], s47 offen offset:3072 sc1
    s_waitcnt vmcnt(11)
    v_mfma_f32_32x32x16_bf16 v[16:31], a[64:67], a[120:123], v[16:31]
    v_mfma_f32_32x32x16_bf16 v[32:47], a[68:71], a[120:123], v[32:47]
    s_add_u32 s47, s47, 4096
    buffer_load_dwordx4 a[168:171], v1, s[4:7], s47 offen sc1
    s_waitcnt vmcnt(11)
    v_mfma_f32_32x32x16_bf16 v[16:31], a[72:75], a[124:127], v[16:31]
    v_mfma_f32_32x32x16_bf16 v[32:47], a[76:79], a[124:127], v[32:47]
    buffer_load_dwordx4 a[172:175], v1, s[4:7], s47 offen offset:1024 sc1
    s_waitcnt vmcnt(11)
    v_mfma_f32_32x32x16_bf16 v[16:31], a[80:83], a[128:131], v[16:31]
    v_mfma_f32_32x32x16_bf16 v[32:47], a[84:87], a[128:131], v[32:47]
    buffer_load_dwordx4 a[176:179], v1, s[4:7], s47 offen offset:2048 sc1
    s_waitcnt vmcnt(11)
    v_mfma_f32_32x32x16_bf16 v[16:31], a[88:91], a[132:135], v[16:31]
    v_mfma_f32_32x32x16_bf16 v[32:47], a[92:95], a[132:135], v[32:47]
    buffer_load_dwordx4 a[180:183], v1, s[4:7], s47 offen offset:3072 sc1
    s_cmp_lg_u32 s18, 0
    s_nop 9
    s_cbranch_scc1 p4a_20
    s_waitcnt vmcnt(11)
    v_mfma_f32_32x32x16_bf16 v[48:63], v[240:243], a[136:139], v[48:63]
    v_accvgpr_read_b32 v96, a248
    v_accvgpr_read_b32 v97, a249
    v_mfma_f32_32x32x16_bf16 v[64:79], v[244:247], a[136:139], v[64:79]
    s_add_u32 s47, s47, 4096
    buffer_load_dwordx4 a[184:187], v1, s[4:7], s47 offen sc1
    s_waitcnt vmcnt(11)
    v_mfma_f32_32x32x16_bf16 v[48:63], v[248:251], a[140:143], v[48:63]
    ds_write_b128 v9, v[32:35] offset:0
    v_accvgpr_read_b32 v98, a250
    v_accvgpr_read_b32 v99, a251
    v_mfma_f32_32x32x16_bf16 v[64:79], v[252:255], a[140:143], v[64:79]
    buffer_load_dwordx4 a[188:191], v1, s[4:7], s47 offen offset:1024 sc1
    s_waitcnt vmcnt(11)
    v_mfma_f32_32x32x16_bf16 v[48:63], a[0:3], a[144:147], v[48:63]
    ds_write_b128 v9, v[36:39] offset:1024
    v_accvgpr_read_b32 v100, a252
    v_accvgpr_read_b32 v101, a253
    v_mfma_f32_32x32x16_bf16 v[64:79], a[4:7], a[144:147], v[64:79]
    s_waitcnt vmcnt(10)
    v_mfma_f32_32x32x16_bf16 v[48:63], a[8:11], a[148:151], v[48:63]
    ds_write_b128 v9, v[40:43] offset:2048
    v_accvgpr_read_b32 v102, a254
    v_accvgpr_read_b32 v103, a255
    v_mfma_f32_32x32x16_bf16 v[64:79], a[12:15], a[148:151], v[64:79]
    s_waitcnt vmcnt(9)
    v_mfma_f32_32x32x16_bf16 v[48:63], a[16:19], a[152:155], v[48:63]
    ds_write_b128 v9, v[44:47] offset:3072
    v_lshlrev_b32 v80, 16, v96
    v_and_b32 v81, 0xffff0000, v96
    v_mfma_f32_32x32x16_bf16 v[64:79], a[20:23], a[152:155], v[64:79]
    s_waitcnt vmcnt(8)
    v_mfma_f32_32x32x16_bf16 v[48:63], a[24:27], a[156:159], v[48:63]
    v_lshlrev_b32 v82, 16, v97
    v_and_b32 v83, 0xffff0000, v97
    v_mfma_f32_32x32x16_bf16 v[64:79], a[28:31], a[156:159], v[64:79]
    s_waitcnt vmcnt(7)
    v_mfma_f32_32x32x16_bf16 v[48:63], a[32:35], a[160:163], v[48:63]
    v_lshlrev_b32 v84, 16, v98
    v_and_b32 v85, 0xffff0000, v98
    v_mfma_f32_32x32x16_bf16 v[64:79], a[36:39], a[160:163], v[64:79]
    s_waitcnt vmcnt(6)
    v_mfma_f32_32x32x16_bf16 v[48:63], a[40:43], a[164:167], v[48:63]
    v_lshlrev_b32 v86, 16, v99
    v_and_b32 v87, 0xffff0000, v99
    v_mfma_f32_32x32x16_bf16 v[64:79], a[44:47], a[164:167], v[64:79]
    s_waitcnt vmcnt(5)
    v_mfma_f32_32x32x16_bf16 v[48:63], a[48:51], a[168:171], v[48:63]
    v_lshlrev_b32 v88, 16, v100
    v_and_b32 v89, 0xffff0000, v100
    v_mfma_f32_32x32x16_bf16 v[64:79], a[52:55], a[168:171], v[64:79]
    s_waitcnt vmcnt(4)
    v_mfma_f32_32x32x16_bf16 v[48:63], a[56:59], a[172:175], v[48:63]
    v_lshlrev_b32 v90, 16, v101
    v_and_b32 v91, 0xffff0000, v101
    v_mfma_f32_32x32x16_bf16 v[64:79], a[60:63], a[172:175], v[64:79]
    s_waitcnt vmcnt(3)
    v_mfma_f32_32x32x16_bf16 v[48:63], a[64:67], a[176:179], v[48:63]
    v_lshlrev_b32 v92, 16, v102
    v_and_b32 v93, 0xffff0000, v102
    v_mfma_f32_32x32x16_bf16 v[64:79], a[68:71], a[176:179], v[64:79]
    s_waitcnt vmcnt(2)
    v_mfma_f32_32x32x16_bf16 v[48:63], a[72:75], a[180:183], v[48:63]
    v_lshlrev_b32 v94, 16, v103
    v_and_b32 v95, 0xffff0000, v103
    v_mfma_f32_32x32x16_bf16 v[64:79], a[76:79], a[180:183], v[64:79]
    s_waitcnt vmcnt(1)
    v_mfma_f32_32x32x16_bf16 v[48:63], a[80:83], a[184:187], v[48:63]
    v_mfma_f32_32x32x16_bf16 v[64:79], a[84:87], a[184:187], v[64:79]
    s_waitcnt vmcnt(0)
    v_mfma_f32_32x32x16_bf16 v[48:63], a[88:91], a[188:191], v[48:63]
    v_mfma_f32_32x32x16_bf16 v[64:79], a[92:95], a[188:191], v[64:79]
    s_nop 10
    ds_write_b128 v10, v[48:51] offset:0
    ds_write_b128 v10, v[52:55] offset:1024
    ds_write_b128 v10, v[56:59] offset:2048
    ds_write_b128 v10, v[60:63] offset:3072
    ds_write_b128 v11, v[64:67] offset:0
    ds_write_b128 v11, v[68:71] offset:1024
    ds_write_b128 v11, v[72:75] offset:2048
    ds_write_b128 v11, v[76:79] offset:3072
    s_mul_i32 s38, s50, 28672
    s_lshl_b32 s23, s51, 11
    s_add_u32 s38, s38, s23
    s_mul_i32 s23, s15, 3670016
    s_add_u32 s38, s38, s23
    s_add_u32 s38, s38, 10518528
    s_mul_i32 s39, s50, 3584
    s_lshl_b32 s23, s51, 8
    s_add_u32 s39, s39, s23
    s_mul_i32 s23, s15, 458752
    s_add_u32 s39, s39, s23
    s_add_u32 s39, s39, 14647296
    v_pk_add_f32 v[16:17], v[16:17], v[80:81]
    v_pk_add_f32 v[18:19], v[18:19], v[82:83]
    v_pk_add_f32 v[20:21], v[20:21], v[84:85]
    v_pk_add_f32 v[22:23], v[22:23], v[86:87]
    v_pk_add_f32 v[24:25], v[24:25], v[88:89]
    v_pk_add_f32 v[26:27], v[26:27], v[90:91]
    v_pk_add_f32 v[28:29], v[28:29], v[92:93]
    v_pk_add_f32 v[30:31], v[30:31], v[94:95]
    s_waitcnt lgkmcnt(0)
    s_barrier
    ds_read_b128 v[32:35], v8 offset:0
    ds_read_b128 v[36:39], v8 offset:1024
    ds_read_b128 v[40:43], v8 offset:2048
    ds_read_b128 v[44:47], v8 offset:3072
    ds_read_b128 v[48:51], v8 offset:4096
    ds_read_b128 v[52:55], v8 offset:5120
    ds_read_b128 v[56:59], v8 offset:6144
    ds_read_b128 v[60:63], v8 offset:7168
    ds_read_b128 v[64:67], v8 offset:8192
    ds_read_b128 v[68:71], v8 offset:9216
    ds_read_b128 v[72:75], v8 offset:10240
    ds_read_b128 v[76:79], v8 offset:11264
    s_waitcnt lgkmcnt(8)
    v_pk_add_f32 v[16:17], v[16:17], v[32:33]
    v_pk_add_f32 v[18:19], v[18:19], v[34:35]
    v_pk_add_f32 v[20:21], v[20:21], v[36:37]
    v_pk_add_f32 v[22:23], v[22:23], v[38:39]
    v_pk_add_f32 v[24:25], v[24:25], v[40:41]
    v_pk_add_f32 v[26:27], v[26:27], v[42:43]
    v_pk_add_f32 v[28:29], v[28:29], v[44:45]
    v_pk_add_f32 v[30:31], v[30:31], v[46:47]
    s_waitcnt lgkmcnt(4)
    v_pk_add_f32 v[16:17], v[16:17], v[48:49]
    v_pk_add_f32 v[18:19], v[18:19], v[50:51]
    v_pk_add_f32 v[20:21], v[20:21], v[52:53]
    v_pk_add_f32 v[22:23], v[22:23], v[54:55]
    v_pk_add_f32 v[24:25], v[24:25], v[56:57]
    v_pk_add_f32 v[26:27], v[26:27], v[58:59]
    v_pk_add_f32 v[28:29], v[28:29], v[60:61]
    v_pk_add_f32 v[30:31], v[30:31], v[62:63]
    s_waitcnt lgkmcnt(0)
    v_pk_add_f32 v[104:105], v[16:17], v[64:65]
    v_pk_add_f32 v[106:107], v[18:19], v[66:67]
    v_pk_add_f32 v[108:109], v[20:21], v[68:69]
    v_pk_add_f32 v[110:111], v[22:23], v[70:71]
    v_pk_add_f32 v[112:113], v[24:25], v[72:73]
    v_pk_add_f32 v[114:115], v[26:27], v[74:75]
    v_pk_add_f32 v[116:117], v[28:29], v[76:77]
    v_pk_add_f32 v[118:119], v[30:31], v[78:79]
    s_nop 1
    s_branch p4j_19
p4a_20:
    s_waitcnt vmcnt(11)
    v_mfma_f32_32x32x16_bf16 v[48:63], v[240:243], a[136:139], v[48:63]
    v_accvgpr_read_b32 v96, a248
    v_accvgpr_read_b32 v97, a249
    v_mfma_f32_32x32x16_bf16 v[64:79], v[244:247], a[136:139], v[64:79]
    s_add_u32 s47, s47, 4096
    buffer_load_dwordx4 a[184:187], v1, s[4:7], s47 offen sc1
    s_waitcnt vmcnt(11)
    v_mfma_f32_32x32x16_bf16 v[48:63], v[248:251], a[140:143], v[48:63]
    ds_write_b128 v10, v[16:19] offset:0
    v_accvgpr_read_b32 v98, a250
    v_accvgpr_read_b32 v99, a251
    v_mfma_f32_32x32x16_bf16 v[64:79], v[252:255], a[140:143], v[64:79]
    buffer_load_dwordx4 a[188:191], v1, s[4:7], s47 offen offset:1024 sc1
    s_waitcnt vmcnt(11)
    v_mfma_f32_32x32x16_bf16 v[48:63], a[0:3], a[144:147], v[48:63]
    ds_write_b128 v10, v[20:23] offset:1024
    v_accvgpr_read_b32 v100, a252
    v_accvgpr_read_b32 v101, a253
    v_mfma_f32_32x32x16_bf16 v[64:79], a[4:7], a[144:147], v[64:79]
    s_waitcnt vmcnt(10)
    v_mfma_f32_32x32x16_bf16 v[48:63], a[8:11], a[148:151], v[48:63]
    ds_write_b128 v10, v[24:27] offset:2048
    v_accvgpr_read_b32 v102, a254
    v_accvgpr_read_b32 v103, a255
    v_mfma_f32_32x32x16_bf16 v[64:79], a[12:15], a[148:151], v[64:79]
    s_waitcnt vmcnt(9)
    v_mfma_f32_32x32x16_bf16 v[48:63], a[16:19], a[152:155], v[48:63]
    ds_write_b128 v10, v[28:31] offset:3072
    v_lshlrev_b32 v80, 16, v96
    v_and_b32 v81, 0xffff0000, v96
    v_mfma_f32_32x32x16_bf16 v[64:79], a[20:23], a[152:155], v[64:79]
    s_waitcnt vmcnt(8)
    v_mfma_f32_32x32x16_bf16 v[48:63], a[24:27], a[156:159], v[48:63]
    ds_write_b128 v11, v[32:35] offset:0
    v_lshlrev_b32 v82, 16, v97
    v_and_b32 v83, 0xffff0000, v97
    v_mfma_f32_32x32x16_bf16 v[64:79], a[28:31], a[156:159], v[64:79]
    s_waitcnt vmcnt(7)
    v_mfma_f32_32x32x16_bf16 v[48:63], a[32:35], a[160:163], v[48:63]
    ds_write_b128 v11, v[36:39] offset:1024
    v_lshlrev_b32 v84, 16, v98
    v_and_b32 v85, 0xffff0000, v98
    v_mfma_f32_32x32x16_bf16 v[64:79], a[36:39], a[160:163], v[64:79]
    s_waitcnt vmcnt(6)
    v_mfma_f32_32x32x16_bf16 v[48:63], a[40:43], a[164:167], v[48:63]
    ds_write_b128 v11, v[40:43] offset:2048
    v_lshlrev_b32 v86, 16, v99
    v_and_b32 v87, 0xffff0000, v99
    v_mfma_f32_32x32x16_bf16 v[64:79], a[44:47], a[164:167], v[64:79]
    s_waitcnt vmcnt(5)
    v_mfma_f32_32x32x16_bf16 v[48:63], a[48:51], a[168:171], v[48:63]
    ds_write_b128 v11, v[44:47] offset:3072
    v_lshlrev_b32 v88, 16, v100
    v_and_b32 v89, 0xffff0000, v100
    v_mfma_f32_32x32x16_bf16 v[64:79], a[52:55], a[168:171], v[64:79]
    s_waitcnt vmcnt(4)
    v_mfma_f32_32x32x16_bf16 v[48:63], a[56:59], a[172:175], v[48:63]
    v_lshlrev_b32 v90, 16, v101
    v_and_b32 v91, 0xffff0000, v101
    v_mfma_f32_32x32x16_bf16 v[64:79], a[60:63], a[172:175], v[64:79]
    s_waitcnt vmcnt(3)
    v_mfma_f32_32x32x16_bf16 v[48:63], a[64:67], a[176:179], v[48:63]
    v_lshlrev_b32 v92, 16, v102
    v_and_b32 v93, 0xffff0000, v102
    v_mfma_f32_32x32x16_bf16 v[64:79], a[68:71], a[176:179], v[64:79]
    s_waitcnt vmcnt(2)
    v_mfma_f32_32x32x16_bf16 v[48:63], a[72:75], a[180:183], v[48:63]
    v_lshlrev_b32 v94, 16, v103
    v_and_b32 v95, 0xffff0000, v103
    v_mfma_f32_32x32x16_bf16 v[64:79], a[76:79], a[180:183], v[64:79]
    s_waitcnt vmcnt(1)
    v_mfma_f32_32x32x16_bf16 v[48:63], a[80:83], a[184:187], v[48:63]
    v_mfma_f32_32x32x16_bf16 v[64:79], a[84:87], a[184:187], v[64:79]
    s_waitcnt vmcnt(0)
    v_mfma_f32_32x32x16_bf16 v[48:63], a[88:91], a[188:191], v[48:63]
    v_mfma_f32_32x32x16_bf16 v[64:79], a[92:95], a[188:191], v[64:79]
    s_nop 11
    ds_write_b128 v9, v[64:67] offset:0
    ds_write_b128 v9, v[68:71] offset:1024
    ds_write_b128 v9, v[72:75] offset:2048
    ds_write_b128 v9, v[76:79] offset:3072
    s_mul_i32 s38, s50, 28672
    s_lshl_b32 s23, s51, 11
    s_add_u32 s38, s38, s23
    s_mul_i32 s23, s15, 3670016
    s_add_u32 s38, s38, s23
    s_add_u32 s38, s38, 10518528
    s_mul_i32 s39, s50, 3584
    s_lshl_b32 s23, s51, 8
    s_add_u32 s39, s39, s23
    s_mul_i32 s23, s15, 458752
    s_add_u32 s39, s39, s23
    s_add_u32 s39, s39, 14647296
    v_pk_add_f32 v[48:49], v[48:49], v[80:81]
    v_pk_add_f32 v[50:51], v[50:51], v[82:83]
    v_pk_add_f32 v[52:53], v[52:53], v[84:85]
    v_pk_add_f32 v[54:55], v[54:55], v[86:87]
    v_pk_add_f32 v[56:57], v[56:57], v[88:89]
    v_pk_add_f32 v[58:59], v[58:59], v[90:91]
    v_pk_add_f32 v[60:61], v[60:61], v[92:93]
    v_pk_add_f32 v[62:63], v[62:63], v[94:95]
    s_waitcnt lgkmcnt(0)
    s_barrier
    ds_read_b128 v[64:67], v8 offset:0
    ds_read_b128 v[68:71], v8 offset:1024
    ds_read_b128 v[72:75], v8 offset:2048
    ds_read_b128 v[76:79], v8 offset:3072
    ds_read_b128 v[16:19], v8 offset:4096
    ds_read_b128 v[20:23], v8 offset:5120
    ds_read_b128 v[24:27], v8 offset:6144
    ds_read_b128 v[28:31], v8 offset:7168
    ds_read_b128 v[32:35], v8 offset:8192
    ds_read_b128 v[36:39], v8 offset:9216
    ds_read_b128 v[40:43], v8 offset:10240
    ds_read_b128 v[44:47], v8 offset:11264
    s_waitcnt lgkmcnt(8)
    v_pk_add_f32 v[48:49], v[48:49], v[64:65]
    v_pk_add_f32 v[50:51], v[50:51], v[66:67]
    v_pk_add_f32 v[52:53], v[52:53], v[68:69]
    v_pk_add_f32 v[54:55], v[54:55], v[70:71]
    v_pk_add_f32 v[56:57], v[56:57], v[72:73]
    v_pk_add_f32 v[58:59], v[58:59], v[74:75]
    v_pk_add_f32 v[60:61], v[60:61], v[76:77]
    v_pk_add_f32 v[62:63], v[62:63], v[78:79]
    s_waitcnt lgkmcnt(4)
    v_pk_add_f32 v[48:49], v[48:49], v[16:17]
    v_pk_add_f32 v[50:51], v[50:51], v[18:19]
    v_pk_add_f32 v[52:53], v[52:53], v[20:21]
    v_pk_add_f32 v[54:55], v[54:55], v[22:23]
    v_pk_add_f32 v[56:57], v[56:57], v[24:25]
    v_pk_add_f32 v[58:59], v[58:59], v[26:27]
    v_pk_add_f32 v[60:61], v[60:61], v[28:29]
    v_pk_add_f32 v[62:63], v[62:63], v[30:31]
    s_waitcnt lgkmcnt(0)
    v_pk_add_f32 v[104:105], v[48:49], v[32:33]
    v_pk_add_f32 v[106:107], v[50:51], v[34:35]
    v_pk_add_f32 v[108:109], v[52:53], v[36:37]
    v_pk_add_f32 v[110:111], v[54:55], v[38:39]
    v_pk_add_f32 v[112:113], v[56:57], v[40:41]
    v_pk_add_f32 v[114:115], v[58:59], v[42:43]
    v_pk_add_f32 v[116:117], v[60:61], v[44:45]
    v_pk_add_f32 v[118:119], v[62:63], v[46:47]
    s_nop 1
p4j_19:
    v_cvt_pk_bf16_f32 v80, v104, v105
    v_cvt_pk_bf16_f32 v81, v106, v107
    v_cvt_pk_bf16_f32 v82, v108, v109
    v_cvt_pk_bf16_f32 v83, v110, v111
    v_cvt_pk_bf16_f32 v84, v112, v113
    v_cvt_pk_bf16_f32 v85, v114, v115
    v_cvt_pk_bf16_f32 v86, v116, v117
    v_cvt_pk_bf16_f32 v87, v118, v119
    s_cmp_lg_u32 s15, 0
    s_nop 0
    s_cbranch_scc1 fin_21
    buffer_store_dwordx4 v[80:83], v1, s[4:7], s38 offen sc1
    buffer_store_dwordx4 v[84:87], v1, s[4:7], s38 offen offset:1024 sc1
    v_pk_add_f32 v[88:89], v[104:105], v[106:107]
    v_pk_mul_f32 v[90:91], v[104:105], v[104:105]
    v_pk_fma_f32 v[90:91], v[106:107], v[106:107], v[90:91]
    v_pk_add_f32 v[88:89], v[88:89], v[108:109]
    v_pk_fma_f32 v[90:91], v[108:109], v[108:109], v[90:91]
    v_pk_add_f32 v[88:89], v[88:89], v[110:111]
    v_pk_fma_f32 v[90:91], v[110:111], v[110:111], v[90:91]
    v_pk_add_f32 v[88:89], v[88:89], v[112:113]
    v_pk_fma_f32 v[90:91], v[112:113], v[112:113], v[90:91]
    v_pk_add_f32 v[88:89], v[88:89], v[114:115]
    v_pk_fma_f32 v[90:91], v[114:115], v[114:115], v[90:91]
    v_pk_add_f32 v[88:89], v[88:89], v[116:117]
    v_pk_fma_f32 v[90:91], v[116:117], v[116:117], v[90:91]
    v_pk_add_f32 v[88:89], v[88:89], v[118:119]
    v_pk_fma_f32 v[90:91], v[118:119], v[118:119], v[90:91]
    v_add_f32 v88, v88, v89
    v_add_f32 v89, v90, v91
    v_mov_b32 v90, v88
    v_mov_b32 v91, v89
    s_nop 0
    v_permlane32_swap_b32 v90, v88
    v_permlane32_swap_b32 v91, v89
    v_pk_add_f32 v[88:89], v[88:89], v[90:91]
    s_mov_b32 exec_hi, 0
    buffer_store_dwordx2 v[88:89], v4, s[4:7], s39 offen sc1
    s_mov_b32 exec_hi, -1
    v_accvgpr_write_b32 a248, v80
    v_accvgpr_write_b32 a249, v81
    v_accvgpr_write_b32 a250, v82
    v_accvgpr_write_b32 a251, v83
    v_accvgpr_write_b32 a252, v84
    v_accvgpr_write_b32 a253, v85
    v_accvgpr_write_b32 a254, v86
    v_accvgpr_write_b32 a255, v87
    s_waitcnt vmcnt(0)
    s_barrier
    s_add_u32 s22, s48, 14336
    v_mov_b32 v15, 1
    s_cmp_eq_u32 s14, 0
    s_cselect_b64 exec, 1, 0
    buffer_atomic_add v15, off, s[4:7], s22 sc1
    s_mov_b64 exec, -1
    s_nop 0
    s_branch main_kernel_next
fin_21:
    s_mul_i32 s20, s50, 28672
    s_lshl_b32 s23, s51, 6
    s_add_u32 s20, s20, s23
    v_mul_u32_u24 v8, 112, v4
    v_lshrrev_b32 v9, 5, v1
    v_and_b32 v9, 16, v9
    v_add_u32 v8, v8, v9
    v_permlane32_swap_b32 v80, v82
    v_permlane32_swap_b32 v81, v83
    v_permlane32_swap_b32 v84, v86
    v_permlane32_swap_b32 v85, v87
    buffer_store_dwordx4 v[80:83], v8, s[8:11], s20 offen
    buffer_store_dwordx4 v[84:87], v8, s[8:11], s20 offen offset:32
    s_nop 1
    s_branch main_kernel_done
main_kernel_next:
    s_add_u32 s15, s15, 1
    s_nop 0
    s_branch main_kernel_layer
main_kernel_done:
    s_endpgm
main_kernel_end:
.section .rodata,"a"
.p2align 6
.amdhsa_kernel prep_kernel
  .amdhsa_next_free_vgpr 128
  .amdhsa_next_free_sgpr 96
  .amdhsa_accum_offset 128
  .amdhsa_group_segment_fixed_size 0
  .amdhsa_kernarg_size 88
  .amdhsa_user_sgpr_count 2
  .amdhsa_user_sgpr_kernarg_segment_ptr 1
  .amdhsa_system_sgpr_workgroup_id_x 1
  .amdhsa_float_denorm_mode_32 3
.end_amdhsa_kernel
.p2align 6
.amdhsa_kernel main_kernel
  .amdhsa_next_free_vgpr 512
  .amdhsa_next_free_sgpr 100
  .amdhsa_accum_offset 256
  .amdhsa_group_segment_fixed_size 0
  .amdhsa_kernarg_size 88
  .amdhsa_user_sgpr_count 2
  .amdhsa_user_sgpr_kernarg_segment_ptr 1
  .amdhsa_system_sgpr_workgroup_id_x 1
  .amdhsa_float_denorm_mode_32 3
.end_amdhsa_kernel
```
